```python
import torch

def _softmax(x, axis=-1):
    return torch.softmax(x, dim=axis)

def _gelu(x):
    return torch.nn.functional.gelu(x, approximate='tanh')

def _silu(x):
    return torch.nn.functional.silu(x)

def _sigmoid(x):
    return torch.sigmoid(x)

def _layernorm(x, axis=-1, eps=1e-05):
    m = x.mean(dim=axis, keepdim=True)
    v = x.var(dim=axis, keepdim=True, unbiased=False)
    return (x - m) / torch.sqrt(v + eps)

def _scatter_add(tgt, idx, src, axis=0):
    return tgt.clone().index_add_(axis, idx, src)

def _segment_sum(src, seg, n):
    out = torch.zeros((n,) + src.shape[1:], dtype=src.dtype)
    return out.index_add_(0, seg, src)

def _pad(x, pw):
    flat = tuple((v for pair in reversed(pw) for v in pair))
    return torch.nn.functional.pad(x, flat)
kernel_name = 'adaLN_cond__sliding_block_cached__geglu_ffn__decode'

def setup_inputs():

    _w = lambda a: (lambda t: t.to(torch.bfloat16) if t.is_floating_point() else t)(torch.as_tensor(a))

    def _A_setup():
        B, Sq, D = (1, 1, 640)
        Hq, Hkv, Sk, Dh = (32, 32, 32768, 192)
        assert Hq % Hkv == 0, (Hq, Hkv)
        return {'x': _w((lambda *s: torch.randn(*s, dtype=torch.bfloat16) * 0.1)(B, Sq, D)), 'k_cache': _w((lambda *s: torch.randn(*s, dtype=torch.bfloat16) * 0.8)(B, Hkv, Sk, Dh)), 'v_cache': _w((lambda *s: torch.randn(*s, dtype=torch.bfloat16) * 1.6)(B, Hkv, Sk, Dh)), 'wq': _w((lambda *s: torch.randn(*s, dtype=torch.bfloat16) * 0.8)(D, Hq * Dh) * D ** (-0.5)), 'wo': _w((lambda *s: torch.randn(*s, dtype=torch.bfloat16) * 1.6)(Hq * Dh, D) * (Hq * Dh) ** (-0.5))}
    _A_in = _A_setup()

    def _B_setup():
        B, S, D, F = (1, 1, 640, 1536)
        return {'x': _w((lambda *s: torch.randn(*s, dtype=torch.bfloat16) * 0.1)(B, S, D)), 'w_gate': _w((lambda *s: torch.randn(*s, dtype=torch.bfloat16) * 0.1)(D, F)), 'w_up': _w((lambda *s: torch.randn(*s, dtype=torch.bfloat16) * 0.1)(D, F)), 'w_down': _w((lambda *s: torch.randn(*s, dtype=torch.bfloat16) * 0.1)(F, D))}
    _B_in = _B_setup()
    return {'A_x': _A_in['x'], 'A_k_cache': _A_in['k_cache'], 'A_v_cache': _A_in['v_cache'], 'A_wq': _A_in['wq'], 'A_wo': _A_in['wo'], 'B_x': _B_in['x'], 'B_w_gate': _B_in['w_gate'], 'B_w_up': _B_in['w_up'], 'B_w_down': _B_in['w_down'], 'c': _w((lambda *s: torch.randn(*s, dtype=torch.bfloat16) * 0.8)(1, 640) * 8.0), 'w_mod': _w((lambda *s: torch.randn(*s, dtype=torch.bfloat16) * 0.8)(640, 6 * 640) * 640 ** (-0.5) * 8.0)}

def reference(A_x, A_k_cache, A_v_cache, A_wq, A_wo, B_x, B_w_gate, B_w_up, B_w_down, c, w_mod):

    def _A_ref(x, k_cache, v_cache, wq, wo):
        B, Sq, D = x.shape
        Hq, Dh = (32, 192)
        Hkv, Sk = (k_cache.shape[1], k_cache.shape[2])
        W = min(4096, max(256, Sk // 4))
        rep = Hq // Hkv
        q = (lambda x, *d: x.permute(*d))((x @ wq).reshape(B, Sq, Hq, Dh), 0, 2, 1, 3)
        k = (lambda x, n, axis: torch.repeat_interleave(x, n, dim=axis))(k_cache[:, :, Sk - W:, :], rep, axis=1)
        v = (lambda x, n, axis: torch.repeat_interleave(x, n, dim=axis))(v_cache[:, :, Sk - W:, :], rep, axis=1)
        scores = torch.einsum('bhqd,bhkd->bhqk', q, k) * Dh ** (-0.5)
        p = _softmax(scores, axis=-1)
        o = torch.einsum('bhqk,bhkd->bhqd', p, v)
        return (lambda x, *d: x.permute(*d))(o, 0, 2, 1, 3).reshape(B, Sq, Hq * Dh) @ wo

    def _B_ref(x, w_gate, w_up, w_down):
        return _gelu(x @ w_gate) * (x @ w_up) @ w_down
    x = A_x
    mod = (_silu(c) @ w_mod).reshape(c.shape[0], 6, 1, -1)
    sa, ca, ga, sb, cb, gb = (mod[:, 0].clone(), mod[:, 1].clone(), mod[:, 2].clone(), mod[:, 3].clone(), mod[:, 4].clone(), mod[:, 5].clone())
    h = _layernorm(x, axis=-1) * (1 + ca) + sa
    x = x + ga * _A_ref(h, A_k_cache, A_v_cache, A_wq, A_wo)
    h = _layernorm(x, axis=-1) * (1 + cb) + sb
    x = x + gb * _B_ref(h, B_w_gate, B_w_up, B_w_down)
    return x
```

```asm
; @launch grid=(256,1,1) block=(1024,1,1) lds=57088
.amdgcn_target "amdgcn-amd-amdhsa--gfx950"
.text
.globl adaLN_cond__sliding_block_cached__geglu_ffn__decode_kernel
.p2align 8
.type adaLN_cond__sliding_block_cached__geglu_ffn__decode_kernel,@function
adaLN_cond__sliding_block_cached__geglu_ffn__decode_kernel:
  s_cmp_ge_u32 s2, 256
  s_cbranch_scc1 L_exit
  s_load_dwordx16 s[16:31], s[0:1], 0
  s_load_dwordx8 s[32:39], s[0:1], 64
  s_load_dwordx4 s[40:43], s[0:1], 96
  v_lshrrev_b32 v2, 6, v0
  v_and_b32 v1, 63, v0
  v_readfirstlane_b32 s3, v2
  v_and_b32 v8, 31, v0
  v_lshlrev_b32 v8, 2, v8
  v_mov_b32 v9, 0
  ds_write_b32 v8, v9 offset:31232
  v_lshrrev_b32 v2, 3, v1
  v_and_b32 v3, 7, v1
  s_and_b32 s4, s2, 7
  s_lshr_b32 s5, s2, 3
  s_lshr_b32 s6, s2, 6
  s_lshl_b32 s7, s4, 2
  s_add_u32 s6, s6, s7
  s_and_b32 s7, s5, 7
  s_and_b32 s9, s3, 7
  s_mul_i32 s8, s6, 12582912
  s_mul_i32 s10, s7, 196608
  s_add_u32 s8, s8, s10
  s_add_u32 s8, s8, 11010048
  s_mul_i32 s10, s9, 3072
  s_add_u32 s8, s8, s10
  s_cmp_lt_u32 s3, 8
  s_cbranch_scc1 L_early
L_kvload:
  v_mul_u32_u24 v8, 384, v2
  v_lshl_add_u32 v8, v3, 4, v8
  s_add_u32 s10, s6, 0
  s_and_b32 s10, s10, 7
  s_mul_i32 s10, s10, 24576
  v_add_u32 v12, s10, v8
  s_add_u32 s10, s6, 1
  s_and_b32 s10, s10, 7
  s_mul_i32 s10, s10, 24576
  v_add_u32 v13, s10, v8
  s_add_u32 s10, s6, 2
  s_and_b32 s10, s10, 7
  s_mul_i32 s10, s10, 24576
  v_add_u32 v14, s10, v8
  s_add_u32 s10, s6, 3
  s_and_b32 s10, s10, 7
  s_mul_i32 s10, s10, 24576
  v_add_u32 v15, s10, v8
  s_add_u32 s10, s6, 4
  s_and_b32 s10, s10, 7
  s_mul_i32 s10, s10, 24576
  v_add_u32 v16, s10, v8
  s_add_u32 s10, s6, 5
  s_and_b32 s10, s10, 7
  s_mul_i32 s10, s10, 24576
  v_add_u32 v17, s10, v8
  s_add_u32 s10, s6, 6
  s_and_b32 s10, s10, 7
  s_mul_i32 s10, s10, 24576
  v_add_u32 v18, s10, v8
  s_add_u32 s10, s6, 7
  s_and_b32 s10, s10, 7
  s_mul_i32 s10, s10, 24576
  v_add_u32 v19, s10, v8
  s_lshl_b32 s10, s9, 2
  v_mov_b32 v9, s10
  v_mov_b32 v10, 1
  v_mov_b32 v11, 0
  s_cmp_lt_u32 s3, 8
  s_cbranch_scc1 L_kvgo_v
  s_waitcnt lgkmcnt(0)
  s_load_dword s44, s[42:43], 0
  s_add_u32 s56, s18, s8
  s_addc_u32 s57, s19, 0
  s_setprio 3
  global_load_dwordx4 v[32:35], v12, s[56:57] offset:0 nt
  global_load_dwordx4 v[36:39], v12, s[56:57] offset:128 nt
  global_load_dwordx4 v[40:43], v12, s[56:57] offset:256 nt
  s_barrier
  s_waitcnt vmcnt(2)
  global_load_dwordx4 v[44:47], v13, s[56:57] offset:0 nt
  s_waitcnt vmcnt(2)
  global_load_dwordx4 v[48:51], v13, s[56:57] offset:128 nt
  s_waitcnt vmcnt(2)
  global_load_dwordx4 v[52:55], v13, s[56:57] offset:256 nt
  s_waitcnt vmcnt(2)
  global_load_dwordx4 v[56:59], v14, s[56:57] offset:0 nt
  s_waitcnt vmcnt(2)
  global_load_dwordx4 v[60:63], v14, s[56:57] offset:128 nt
  s_waitcnt vmcnt(2)
  global_load_dwordx4 v[64:67], v14, s[56:57] offset:256 nt
  s_waitcnt vmcnt(2)
  global_load_dwordx4 v[68:71], v15, s[56:57] offset:0 nt
  s_waitcnt vmcnt(2)
  global_load_dwordx4 v[72:75], v15, s[56:57] offset:128 nt
  s_waitcnt vmcnt(2)
  global_load_dwordx4 v[76:79], v15, s[56:57] offset:256 nt
  s_waitcnt vmcnt(2)
  global_load_dwordx4 v[80:83], v16, s[56:57] offset:0 nt
  s_waitcnt vmcnt(2)
  global_load_dwordx4 v[84:87], v16, s[56:57] offset:128 nt
  s_waitcnt vmcnt(2)
  global_load_dwordx4 v[88:91], v16, s[56:57] offset:256 nt
  s_waitcnt vmcnt(2)
  global_load_dwordx4 v[92:95], v17, s[56:57] offset:0 nt
  s_waitcnt vmcnt(2)
  global_load_dwordx4 v[96:99], v17, s[56:57] offset:128 nt
  s_waitcnt vmcnt(2)
  global_load_dwordx4 v[100:103], v17, s[56:57] offset:256 nt
  s_waitcnt vmcnt(2)
  global_load_dwordx4 v[104:107], v18, s[56:57] offset:0 nt
  s_waitcnt vmcnt(2)
  global_load_dwordx4 v[108:111], v18, s[56:57] offset:128 nt
  s_waitcnt vmcnt(2)
  global_load_dwordx4 v[112:115], v18, s[56:57] offset:256 nt
  s_waitcnt vmcnt(2)
  global_load_dwordx4 v[116:119], v19, s[56:57] offset:0 nt
  ds_write_b32 v9, v10 offset:31312
  s_waitcnt vmcnt(2)
  global_load_dwordx4 v[120:123], v19, s[56:57] offset:128 nt
  s_waitcnt vmcnt(2)
  global_load_dwordx4 v[124:127], v19, s[56:57] offset:256 nt
  s_setprio 0
  s_waitcnt lgkmcnt(0)
  s_mul_i32 s44, s44, 0x19660d
  s_add_u32 s44, s44, 0x3c6ef35f
  s_mov_b32 s45, 0x7060500
  s_mov_b32 s46, 0x7060501
  s_mov_b32 s47, 0x7060502
  s_mov_b32 s48, 0x7060503
  s_bfe_u32 s49, s44, 0x80000
  s_bfe_u32 s50, s44, 0x80008
  s_bfe_u32 s51, s44, 0x80010
  s_bfe_u32 s60, s44, 0x80018
  s_mov_b32 s52, 0xffff0000
  s_mov_b32 s53, 0x3fb8aa3b
  s_mov_b32 s54, 0x3d93cd3a
  v_and_b32 v28, 1, v1
  v_lshlrev_b32 v28, 4, v28
  v_mov_b32 v29, 0xffff
  v_lshlrev_b32 v29, v28, v29
  v_lshrrev_b32 v28, 1, v3
  v_cmp_eq_u32 vcc, 0, v28
  s_nop 1
  v_cndmask_b32 v4, 0, v29, vcc
  v_cmp_eq_u32 vcc, 1, v28
  s_nop 1
  v_cndmask_b32 v5, 0, v29, vcc
  v_cmp_eq_u32 vcc, 2, v28
  s_nop 1
  v_cndmask_b32 v6, 0, v29, vcc
  v_cmp_eq_u32 vcc, 3, v28
  s_nop 1
  v_cndmask_b32 v7, 0, v29, vcc
  v_mov_b32 v28, 0
  s_mov_b32 s55, 0
L_lp_1:
  ds_read_b32 v29, v28 offset:31232
  s_waitcnt lgkmcnt(0)
  v_cmp_ne_u32 vcc, 6, v29
  s_cbranch_vccz L_lpd_2
  s_sleep 1
  s_add_u32 s55, s55, 1
  s_cmp_lt_u32 s55, 16777216
  s_cbranch_scc1 L_lp_1
L_lpd_2:
  ds_read_b32 v29, v28 offset:31244
  v_lshlrev_b32 v28, 4, v3
  ds_read_b128 v[16:19], v28 offset:30720
  ds_read_b128 v[20:23], v28 offset:30848
  ds_read_b128 v[24:27], v28 offset:30976
  s_waitcnt lgkmcnt(0)
  v_readfirstlane_b32 s66, v29
  s_waitcnt vmcnt(21)
  v_dot2_f32_bf16 v8, v32, v16, 0
  v_dot2_f32_bf16 v30, v36, v20, 0
  v_dot2_f32_bf16 v31, v40, v24, 0
  v_dot2_f32_bf16 v8, v33, v17, v8
  v_dot2_f32_bf16 v30, v37, v21, v30
  v_dot2_f32_bf16 v31, v41, v25, v31
  v_dot2_f32_bf16 v8, v34, v18, v8
  v_dot2_f32_bf16 v30, v38, v22, v30
  v_dot2_f32_bf16 v31, v42, v26, v31
  v_dot2_f32_bf16 v8, v35, v19, v8
  v_dot2_f32_bf16 v30, v39, v23, v30
  v_dot2_f32_bf16 v31, v43, v27, v31
  s_nop 2
  v_add_f32 v30, v30, v31
  v_add_f32 v8, v8, v30
  s_waitcnt vmcnt(18)
  v_dot2_f32_bf16 v9, v44, v16, 0
  v_dot2_f32_bf16 v30, v48, v20, 0
  v_dot2_f32_bf16 v31, v52, v24, 0
  v_dot2_f32_bf16 v9, v45, v17, v9
  v_dot2_f32_bf16 v30, v49, v21, v30
  v_dot2_f32_bf16 v31, v53, v25, v31
  v_dot2_f32_bf16 v9, v46, v18, v9
  v_dot2_f32_bf16 v30, v50, v22, v30
  v_dot2_f32_bf16 v31, v54, v26, v31
  v_dot2_f32_bf16 v9, v47, v19, v9
  v_dot2_f32_bf16 v30, v51, v23, v30
  v_dot2_f32_bf16 v31, v55, v27, v31
  s_nop 2
  v_add_f32 v30, v30, v31
  v_add_f32 v9, v9, v30
  s_waitcnt vmcnt(15)
  v_dot2_f32_bf16 v10, v56, v16, 0
  v_dot2_f32_bf16 v30, v60, v20, 0
  v_dot2_f32_bf16 v31, v64, v24, 0
  v_dot2_f32_bf16 v10, v57, v17, v10
  v_dot2_f32_bf16 v30, v61, v21, v30
  v_dot2_f32_bf16 v31, v65, v25, v31
  v_dot2_f32_bf16 v10, v58, v18, v10
  v_dot2_f32_bf16 v30, v62, v22, v30
  v_dot2_f32_bf16 v31, v66, v26, v31
  v_dot2_f32_bf16 v10, v59, v19, v10
  v_dot2_f32_bf16 v30, v63, v23, v30
  v_dot2_f32_bf16 v31, v67, v27, v31
  s_nop 2
  v_add_f32 v30, v30, v31
  v_add_f32 v10, v10, v30
  s_waitcnt vmcnt(12)
  v_dot2_f32_bf16 v11, v68, v16, 0
  v_dot2_f32_bf16 v30, v72, v20, 0
  v_dot2_f32_bf16 v31, v76, v24, 0
  v_dot2_f32_bf16 v11, v69, v17, v11
  v_dot2_f32_bf16 v30, v73, v21, v30
  v_dot2_f32_bf16 v31, v77, v25, v31
  v_dot2_f32_bf16 v11, v70, v18, v11
  v_dot2_f32_bf16 v30, v74, v22, v30
  v_dot2_f32_bf16 v31, v78, v26, v31
  v_dot2_f32_bf16 v11, v71, v19, v11
  v_dot2_f32_bf16 v30, v75, v23, v30
  v_dot2_f32_bf16 v31, v79, v27, v31
  s_nop 2
  v_add_f32 v30, v30, v31
  v_add_f32 v11, v11, v30
  s_waitcnt vmcnt(9)
  v_dot2_f32_bf16 v12, v80, v16, 0
  v_dot2_f32_bf16 v30, v84, v20, 0
  v_dot2_f32_bf16 v31, v88, v24, 0
  v_dot2_f32_bf16 v12, v81, v17, v12
  v_dot2_f32_bf16 v30, v85, v21, v30
  v_dot2_f32_bf16 v31, v89, v25, v31
  v_dot2_f32_bf16 v12, v82, v18, v12
  v_dot2_f32_bf16 v30, v86, v22, v30
  v_dot2_f32_bf16 v31, v90, v26, v31
  v_dot2_f32_bf16 v12, v83, v19, v12
  v_dot2_f32_bf16 v30, v87, v23, v30
  v_dot2_f32_bf16 v31, v91, v27, v31
  s_nop 2
  v_add_f32 v30, v30, v31
  v_add_f32 v12, v12, v30
  s_waitcnt vmcnt(6)
  v_dot2_f32_bf16 v13, v92, v16, 0
  v_dot2_f32_bf16 v30, v96, v20, 0
  v_dot2_f32_bf16 v31, v100, v24, 0
  v_dot2_f32_bf16 v13, v93, v17, v13
  v_dot2_f32_bf16 v30, v97, v21, v30
  v_dot2_f32_bf16 v31, v101, v25, v31
  v_dot2_f32_bf16 v13, v94, v18, v13
  v_dot2_f32_bf16 v30, v98, v22, v30
  v_dot2_f32_bf16 v31, v102, v26, v31
  v_dot2_f32_bf16 v13, v95, v19, v13
  v_dot2_f32_bf16 v30, v99, v23, v30
  v_dot2_f32_bf16 v31, v103, v27, v31
  s_nop 2
  v_add_f32 v30, v30, v31
  v_add_f32 v13, v13, v30
  s_waitcnt vmcnt(3)
  v_dot2_f32_bf16 v14, v104, v16, 0
  v_dot2_f32_bf16 v30, v108, v20, 0
  v_dot2_f32_bf16 v31, v112, v24, 0
  v_dot2_f32_bf16 v14, v105, v17, v14
  v_dot2_f32_bf16 v30, v109, v21, v30
  v_dot2_f32_bf16 v31, v113, v25, v31
  v_dot2_f32_bf16 v14, v106, v18, v14
  v_dot2_f32_bf16 v30, v110, v22, v30
  v_dot2_f32_bf16 v31, v114, v26, v31
  v_dot2_f32_bf16 v14, v107, v19, v14
  v_dot2_f32_bf16 v30, v111, v23, v30
  v_dot2_f32_bf16 v31, v115, v27, v31
  s_nop 2
  v_add_f32 v30, v30, v31
  v_add_f32 v14, v14, v30
  s_waitcnt vmcnt(0)
  v_dot2_f32_bf16 v15, v116, v16, 0
  v_dot2_f32_bf16 v30, v120, v20, 0
  v_dot2_f32_bf16 v31, v124, v24, 0
  v_dot2_f32_bf16 v15, v117, v17, v15
  v_dot2_f32_bf16 v30, v121, v21, v30
  v_dot2_f32_bf16 v31, v125, v25, v31
  v_dot2_f32_bf16 v15, v118, v18, v15
  v_dot2_f32_bf16 v30, v122, v22, v30
  v_dot2_f32_bf16 v31, v126, v26, v31
  v_dot2_f32_bf16 v15, v119, v19, v15
  v_dot2_f32_bf16 v30, v123, v23, v30
  v_dot2_f32_bf16 v31, v127, v27, v31
  s_nop 2
  v_add_f32 v30, v30, v31
  v_add_f32 v15, v15, v30
  v_add_f32_dpp v8, v8, v8 quad_perm:[1,0,3,2] row_mask:0xf bank_mask:0xf
  v_add_f32_dpp v9, v9, v9 quad_perm:[1,0,3,2] row_mask:0xf bank_mask:0xf
  v_add_f32_dpp v10, v10, v10 quad_perm:[1,0,3,2] row_mask:0xf bank_mask:0xf
  v_add_f32_dpp v11, v11, v11 quad_perm:[1,0,3,2] row_mask:0xf bank_mask:0xf
  v_add_f32_dpp v12, v12, v12 quad_perm:[1,0,3,2] row_mask:0xf bank_mask:0xf
  v_add_f32_dpp v13, v13, v13 quad_perm:[1,0,3,2] row_mask:0xf bank_mask:0xf
  v_add_f32_dpp v14, v14, v14 quad_perm:[1,0,3,2] row_mask:0xf bank_mask:0xf
  v_add_f32_dpp v15, v15, v15 quad_perm:[1,0,3,2] row_mask:0xf bank_mask:0xf
  v_add_f32_dpp v8, v8, v8 quad_perm:[2,3,0,1] row_mask:0xf bank_mask:0xf
  v_add_f32_dpp v9, v9, v9 quad_perm:[2,3,0,1] row_mask:0xf bank_mask:0xf
  v_add_f32_dpp v10, v10, v10 quad_perm:[2,3,0,1] row_mask:0xf bank_mask:0xf
  v_add_f32_dpp v11, v11, v11 quad_perm:[2,3,0,1] row_mask:0xf bank_mask:0xf
  v_add_f32_dpp v12, v12, v12 quad_perm:[2,3,0,1] row_mask:0xf bank_mask:0xf
  v_add_f32_dpp v13, v13, v13 quad_perm:[2,3,0,1] row_mask:0xf bank_mask:0xf
  v_add_f32_dpp v14, v14, v14 quad_perm:[2,3,0,1] row_mask:0xf bank_mask:0xf
  v_add_f32_dpp v15, v15, v15 quad_perm:[2,3,0,1] row_mask:0xf bank_mask:0xf
  v_add_f32_dpp v8, v8, v8 row_half_mirror row_mask:0xf bank_mask:0xf
  v_add_f32_dpp v9, v9, v9 row_half_mirror row_mask:0xf bank_mask:0xf
  v_add_f32_dpp v10, v10, v10 row_half_mirror row_mask:0xf bank_mask:0xf
  v_add_f32_dpp v11, v11, v11 row_half_mirror row_mask:0xf bank_mask:0xf
  v_add_f32_dpp v12, v12, v12 row_half_mirror row_mask:0xf bank_mask:0xf
  v_add_f32_dpp v13, v13, v13 row_half_mirror row_mask:0xf bank_mask:0xf
  v_add_f32_dpp v14, v14, v14 row_half_mirror row_mask:0xf bank_mask:0xf
  v_add_f32_dpp v15, v15, v15 row_half_mirror row_mask:0xf bank_mask:0xf
  v_cvt_pk_bf16_f32 v8, v8, v8
  v_cvt_pk_bf16_f32 v9, v9, v9
  v_cvt_pk_bf16_f32 v10, v10, v10
  v_cvt_pk_bf16_f32 v11, v11, v11
  v_cvt_pk_bf16_f32 v12, v12, v12
  v_cvt_pk_bf16_f32 v13, v13, v13
  v_cvt_pk_bf16_f32 v14, v14, v14
  v_cvt_pk_bf16_f32 v15, v15, v15
  v_and_b32 v8, s52, v8
  v_and_b32 v9, s52, v9
  v_and_b32 v10, s52, v10
  v_and_b32 v11, s52, v11
  v_and_b32 v12, s52, v12
  v_and_b32 v13, s52, v13
  v_and_b32 v14, s52, v14
  v_and_b32 v15, s52, v15
  v_mul_f32 v8, s54, v8
  v_mul_f32 v9, s54, v9
  v_mul_f32 v10, s54, v10
  v_mul_f32 v11, s54, v11
  v_mul_f32 v12, s54, v12
  v_mul_f32 v13, s54, v13
  v_mul_f32 v14, s54, v14
  v_mul_f32 v15, s54, v15
  v_cvt_pk_bf16_f32 v8, v8, v8
  v_cvt_pk_bf16_f32 v9, v9, v9
  v_cvt_pk_bf16_f32 v10, v10, v10
  v_cvt_pk_bf16_f32 v11, v11, v11
  v_cvt_pk_bf16_f32 v12, v12, v12
  v_cvt_pk_bf16_f32 v13, v13, v13
  v_cvt_pk_bf16_f32 v14, v14, v14
  v_cvt_pk_bf16_f32 v15, v15, v15
  v_and_b32 v8, s52, v8
  v_and_b32 v9, s52, v9
  v_and_b32 v10, s52, v10
  v_and_b32 v11, s52, v11
  v_and_b32 v12, s52, v12
  v_and_b32 v13, s52, v13
  v_and_b32 v14, s52, v14
  v_and_b32 v15, s52, v15
  v_max3_f32 v16, v8, v9, v10
  v_max3_f32 v17, v11, v12, v13
  v_max3_f32 v16, v14, v15, v16
  v_max_f32 v16, v16, v17
  s_nop 1
  v_max_f32_dpp v16, v16, v16 row_ror:8 row_mask:0xf bank_mask:0xf
  v_mov_b32 v17, v16
  s_nop 1
  v_permlane16_swap_b32 v16, v17
  v_max_f32 v16, v16, v17
  v_mov_b32 v17, v16
  s_nop 1
  v_permlane32_swap_b32 v16, v17
  v_max_f32 v16, v16, v17
  v_sub_f32 v20, v8, v16
  v_sub_f32 v21, v9, v16
  v_sub_f32 v22, v10, v16
  v_sub_f32 v23, v11, v16
  v_sub_f32 v24, v12, v16
  v_sub_f32 v25, v13, v16
  v_sub_f32 v26, v14, v16
  v_sub_f32 v27, v15, v16
  v_mul_f32 v20, s53, v20
  v_mul_f32 v21, s53, v21
  v_mul_f32 v22, s53, v22
  v_mul_f32 v23, s53, v23
  v_mul_f32 v24, s53, v24
  v_mul_f32 v25, s53, v25
  v_mul_f32 v26, s53, v26
  v_mul_f32 v27, s53, v27
  v_exp_f32 v20, v20
  v_exp_f32 v21, v21
  v_exp_f32 v22, v22
  v_exp_f32 v23, v23
  v_exp_f32 v24, v24
  v_exp_f32 v25, v25
  v_exp_f32 v26, v26
  v_exp_f32 v27, v27
  v_cvt_pk_bf16_f32 v8, v20, v20
  v_cvt_pk_bf16_f32 v9, v21, v21
  v_cvt_pk_bf16_f32 v10, v22, v22
  v_cvt_pk_bf16_f32 v11, v23, v23
  v_cvt_pk_bf16_f32 v12, v24, v24
  v_cvt_pk_bf16_f32 v13, v25, v25
  v_cvt_pk_bf16_f32 v14, v26, v26
  v_cvt_pk_bf16_f32 v15, v27, v27
  s_lshl_b32 s10, s9, 8
  v_lshl_add_u32 v28, v2, 5, s10
  ds_write_b128 v28, v[8:11] offset:31744
  ds_write_b128 v28, v[12:15] offset:31760
  v_add_f32 v20, v20, v21
  v_add_f32 v22, v22, v23
  v_add_f32 v24, v24, v25
  v_add_f32 v26, v26, v27
  v_add_f32 v20, v20, v22
  v_add_f32 v24, v24, v26
  v_add_f32 v18, v20, v24
  s_lshl_b32 s10, s9, 2
  v_mov_b32 v28, s10
  v_mov_b32 v29, 1
  s_waitcnt lgkmcnt(0)
  ds_write_b32 v28, v29 offset:31248
  v_add_f32_dpp v18, v18, v18 row_ror:8 row_mask:0xf bank_mask:0xf
  v_mov_b32 v17, v18
  s_nop 1
  v_permlane16_swap_b32 v18, v17
  v_add_f32 v18, v18, v17
  v_mov_b32 v17, v18
  s_nop 1
  v_permlane32_swap_b32 v18, v17
  v_add_f32 v18, v18, v17
  v_mov_b32 v17, s44
  v_mov_b32 v19, s44
  s_lshl_b32 s10, s6, 6
  s_lshl_b32 s11, s7, 3
  s_add_u32 s11, s11, s10
  s_add_u32 s11, s11, s9
  s_lshl_b32 s11, s11, 4
  s_add_u32 s11, s11, 327680
  v_mov_b32 v27, s11
  s_mov_b32 exec_lo, 0x1
  s_mov_b32 exec_hi, 0x0
  s_cmp_eq_u32 s66, 1
  s_cbranch_scc0 L_ls_3
  global_store_dwordx4 v27, v[16:19], s[42:43]
  s_branch L_lsd_4
L_ls_3:
  global_store_dwordx4 v27, v[16:19], s[42:43] sc1
L_lsd_4:
  s_mov_b64 exec, -1
  v_lshrrev_b32 v64, 4, v1
  v_mov_b32 v65, s44
  s_cmp_lt_u32 s5, 20
  s_cbranch_scc0 L_pre_nog
  s_cmp_eq_u32 s9, 6
  s_cbranch_scc0 L_pre_nog
  s_lshl_b32 s10, s5, 5
  v_lshl_add_u32 v28, v3, 2, s10
  v_add_u32 v28, v28, v64
  v_lshlrev_b32 v29, 1, v28
  global_load_ushort v11, v29, s[16:17]
  v_and_b32 v29, 8, v1
  v_mul_u32_u24 v29, 7680, v29
  v_lshl_add_u32 v28, v28, 3, v29
  v_add_u32 v28, 14336, v28
  v_add_u32 v27, 30720, v28
  v_add_u32 v26, 5120, v28
  v_add_u32 v25, 35840, v28
  v_add_u32 v24, 10240, v28
  v_add_u32 v23, 40960, v28
  v_add_u32 v22, 15360, v28
  v_add_u32 v21, 46080, v28
  s_mov_b32 s55, 0
L_gp_5:
  global_load_dwordx2 v[32:33], v28, s[42:43] sc1
  global_load_dwordx2 v[34:35], v27, s[42:43] sc1
  global_load_dwordx2 v[36:37], v26, s[42:43] sc1
  global_load_dwordx2 v[38:39], v25, s[42:43] sc1
  global_load_dwordx2 v[40:41], v24, s[42:43] sc1
  global_load_dwordx2 v[42:43], v23, s[42:43] sc1
  global_load_dwordx2 v[44:45], v22, s[42:43] sc1
  global_load_dwordx2 v[46:47], v21, s[42:43] sc1
  s_waitcnt vmcnt(0)
  v_xor_b32 v33, s44, v33
  v_xor_b32 v35, s44, v35
  v_xor_b32 v37, s44, v37
  v_xor_b32 v39, s44, v39
  v_xor_b32 v41, s44, v41
  v_xor_b32 v43, s44, v43
  v_xor_b32 v45, s44, v45
  v_xor_b32 v47, s44, v47
  v_or3_b32 v30, v33, v35, v37
  v_or3_b32 v30, v30, v39, v41
  v_or3_b32 v30, v30, v43, v45
  v_or_b32 v30, v30, v47
  v_cmp_ne_u32 vcc, 0, v30
  s_cbranch_vccz L_gpd_6
  s_mov_b64 exec, vcc
  s_add_u32 s55, s55, 1
  s_cmp_lt_u32 s55, 1500000
  s_cbranch_scc1 L_gp_5
L_gpd_6:
  s_mov_b64 exec, -1
  v_add_f32 v8, v32, v34
  v_add_f32 v10, v36, v38
  v_add_f32 v9, v40, v42
  v_add_f32 v12, v44, v46
  v_add_f32_dpp v8, v8, v8 row_ror:8 row_mask:0xf bank_mask:0xf
  v_add_f32_dpp v9, v9, v9 row_ror:8 row_mask:0xf bank_mask:0xf
  v_add_f32_dpp v10, v10, v10 row_ror:8 row_mask:0xf bank_mask:0xf
  v_add_f32_dpp v12, v12, v12 row_ror:8 row_mask:0xf bank_mask:0xf
  v_cvt_pk_bf16_f32 v8, v8, v8
  v_cvt_pk_bf16_f32 v9, v9, v9
  v_cvt_pk_bf16_f32 v10, v10, v10
  v_cvt_pk_bf16_f32 v12, v12, v12
  v_and_b32 v8, s52, v8
  v_and_b32 v9, s52, v9
  v_and_b32 v10, s52, v10
  v_and_b32 v12, s52, v12
  v_add_f32 v9, 1.0, v9
  v_cvt_pk_bf16_f32 v9, v9, v9
  v_and_b32 v9, s52, v9
  v_lshlrev_b32 v11, 16, v11
  v_lshlrev_b32 v28, 4, v1
  ds_write_b128 v28, v[8:11] offset:54272
  v_lshlrev_b32 v28, 2, v1
  ds_write_b32 v28, v12 offset:55296
L_pre_nog:
  s_and_b32 s10, s9, 3
  s_min_u32 s11, s5, 19
  s_lshl_b32 s12, s11, 2
  s_add_u32 s12, s12, s10
  v_and_b32 v80, 1, v1
  s_lshl_b32 s11, s10, 1
  v_add_u32 v76, s11, v80
  v_lshl_add_u32 v76, v64, 4, v76
  v_lshlrev_b32 v76, 2, v76
  s_lshl_b32 s10, s12, 3
  v_lshl_add_u32 v28, v80, 2, s10
  v_add_u32 v28, v28, v64
  v_lshlrev_b32 v75, 1, v28
  s_lshl_b32 s10, s12, 5
  v_lshl_add_u32 v80, v80, 4, s10
  v_lshrrev_b32 v28, 1, v1
  v_mul_u32_u24 v77, 2560, v28
  v_add_u32 v77, v77, v80
  v_add_u32 v77, 1540096, v77
  v_add_u32 v78, 81920, v77
  v_add_u32 v79, 163840, v77
  s_cmp_lt_u32 s5, 20
  s_cbranch_scc0 L_pre_d
  s_cmp_lt_u32 s9, 3
  s_cselect_b32 s58, s28, s30
  s_cselect_b32 s59, s29, s31
  s_cselect_b32 s13, 0, 3
  s_cselect_b32 s14, 0, 64
  s_sub_u32 s13, s9, s13
  s_min_u32 s13, s13, 2
  s_mul_i32 s10, s5, 98304
  s_mul_i32 s11, s4, 384
  s_add_u32 s10, s10, s11
  s_lshl_b32 s11, s13, 7
  s_add_u32 s10, s10, s11
  s_add_u32 s58, s58, s10
  s_addc_u32 s59, s59, 0
  v_and_b32 v28, 1, v2
  v_lshl_add_u32 v28, v28, 2, v64
  v_mul_u32_u24 v66, 3072, v28
  v_lshl_add_u32 v66, v3, 4, v66
  v_add_u32 v67, 24576, v66
  v_add_u32 v68, 49152, v66
  v_add_u32 v69, 73728, v66
  s_lshl_b32 s10, s5, 7
  s_add_u32 s10, s10, 1785856
  v_mul_u32_u24 v82, 2560, v2
  v_lshl_add_u32 v82, v3, 4, v82
  v_add_u32 v82, s10, v82
  v_add_u32 v83, 20480, v82
  v_add_u32 v84, 40960, v82
  s_mul_i32 s10, s4, 110592
  s_mul_i32 s11, s5, 1536
  s_add_u32 s10, s10, s11
  s_lshl_b32 s11, s13, 9
  s_add_u32 s10, s10, s11
  s_add_u32 s10, s10, s14
  s_add_u32 s10, s10, 589824
  v_lshrrev_b32 v28, 1, v3
  v_lshl_add_u32 v85, v28, 7, s10
  v_and_b32 v28, 1, v3
  v_lshl_add_u32 v85, v28, 5, v85
  v_and_b32 v28, 16, v1
  v_add_u32 v85, v85, v28
  v_lshrrev_b32 v28, 5, v1
  v_mul_u32_u24 v28, 36864, v28
  v_add_u32 v86, v85, v28
  v_add_u32 v86, 36864, v86
  s_mul_i32 s10, s4, 6144
  s_lshl_b32 s11, s5, 4
  s_add_u32 s10, s10, s11
  s_add_u32 s10, s10, 1474560
  v_min_u32 v87, 11, v1
  v_lshl_add_u32 v87, v87, 9, s10
  v_and_b32 v28, 1, v3
  v_lshl_add_u32 v72, v64, 1, v28
  v_lshlrev_b32 v72, 4, v72
  v_lshrrev_b32 v28, 1, v3
  v_lshl_add_u32 v72, v28, 2, v72
  v_lshlrev_b32 v73, 4, v2
  s_branch L_pre_gd
L_pre_d:
  s_sub_u32 s13, s5, 20
  s_mul_i32 s10, s4, 192
  s_lshl_b32 s11, s13, 4
  s_add_u32 s10, s10, s11
  s_mul_i32 s10, s10, 1280
  s_min_u32 s14, s9, 4
  s_lshl_b32 s11, s14, 8
  s_add_u32 s10, s10, s11
  s_add_u32 s58, s32, s10
  s_addc_u32 s59, s33, 0
  v_and_b32 v28, 15, v1
  v_mul_u32_u24 v66, 1280, v64
  v_lshl_add_u32 v66, v28, 4, v66
  v_add_u32 v67, 5120, v66
  v_add_u32 v68, 10240, v66
  v_add_u32 v69, 15360, v66
  s_mul_i32 s10, s4, 110592
  s_lshl_b32 s11, s13, 7
  s_add_u32 s10, s10, s11
  s_add_u32 s10, s10, 589824
  v_lshl_add_u32 v29, v3, 4, s10
  v_mul_u32_u24 v82, 1536, v2
  v_add_u32 v82, v82, v29
  v_add_u32 v83, 12288, v82
  v_add_u32 v84, 24576, v82
  s_mul_i32 s10, s4, 12
  s_add_u32 s10, s10, s13
  s_mul_i32 s10, s10, 2560
  s_lshl_b32 s11, s14, 9
  s_add_u32 s10, s10, s11
  s_add_u32 s10, s10, 1540096
  v_lshl_add_u32 v85, v28, 5, s10
  v_and_b32 v28, 16, v1
  v_add_u32 v85, v85, v28
  v_mov_b32 v86, v85
  s_mul_i32 s10, s4, 6144
  s_lshl_b32 s11, s13, 9
  s_add_u32 s10, s10, s11
  s_add_u32 s10, s10, 1474560
  v_and_b32 v28, 31, v1
  v_lshl_add_u32 v87, v28, 4, s10
  v_lshlrev_b32 v73, 4, v64
  v_and_b32 v28, 3, v3
  v_lshl_add_u32 v72, v28, 2, v73
L_pre_gd:
  s_mul_i32 s14, s5, 26
  s_lshr_b32 s14, s14, 8
  s_min_u32 s14, s14, 2
  s_mul_i32 s15, s14, 10
  s_sub_u32 s15, s5, s15
  s_min_u32 s15, s15, 9
  s_mul_i32 s10, s4, 3
  s_add_u32 s61, s10, s14
  s_lshl_b32 s10, s61, 3
  s_add_u32 s10, s10, s9
  s_lshl_b32 s11, s10, 10
  s_add_u32 s11, s11, 393216
  v_lshl_add_u32 v88, v1, 4, s11
  s_mul_i32 s10, s10, 40960
  s_lshl_b32 s11, s15, 7
  s_add_u32 s10, s10, s11
  s_add_u32 s56, s24, s10
  s_addc_u32 s57, s25, 0
  v_mul_u32_u24 v70, 5120, v2
  v_lshl_add_u32 v70, v3, 4, v70
  s_mul_i32 s10, s9, 576
  v_lshl_add_u32 v89, v3, 5, s10
  v_and_b32 v90, 16, v1
  v_add_u32 v89, v89, v90
  v_lshrrev_b32 v90, 5, v1
  v_mul_u32_u24 v90, 256, v90
  v_add_u32 v89, v89, v90
  s_and_b32 s10, s9, 1
  s_lshl_b32 s10, s10, 7
  v_mul_u32_u24 v90, 576, v3
  v_lshl_add_u32 v90, v2, 4, v90
  v_add_u32 v90, s10, v90
  s_lshl_b32 s11, s14, 3
  s_add_u32 s11, s11, s4
  s_mul_i32 s11, s11, 2560
  s_add_u32 s10, s10, s11
  s_lshl_b32 s11, s15, 8
  s_add_u32 s10, s10, s11
  s_add_u32 s10, s10, 1785856
  v_lshl_add_u32 v91, v2, 4, s10
  v_min_u32 v28, 5, v2
  s_mul_i32 s10, s9, 6
  v_add_u32 v28, s10, v28
  v_mul_u32_u24 v92, 1600, v3
  v_lshl_add_u32 v92, v28, 4, v92
  s_mul_i32 s10, s6, 6144
  s_lshl_b32 s11, s7, 4
  s_add_u32 s10, s10, s11
  s_add_u32 s10, s10, 393216
  v_lshl_add_u32 v94, v28, 7, s10
  v_lshlrev_b32 v93, 2, v3
  v_lshlrev_b32 v95, 4, v1
  s_cmp_lg_u32 s9, 7
  s_cbranch_scc1 L_k_nostat
  s_lshl_b32 s10, s6, 10
  s_add_u32 s10, s10, 327680
  v_lshl_add_u32 v28, v1, 4, s10
  s_mov_b32 s55, 0
L_gp_7:
  global_load_dwordx4 v[20:23], v28, s[42:43] sc1
  s_waitcnt vmcnt(0)
  v_xor_b32 v21, s44, v21
  v_xor_b32 v23, s44, v23
  v_or_b32 v24, v21, v23
  v_cmp_ne_u32 vcc, 0, v24
  s_cbranch_vccz L_gpd_8
  s_mov_b64 exec, vcc
  s_sleep 2
  s_add_u32 s55, s55, 1
  s_cmp_lt_u32 s55, 1500000
  s_cbranch_scc1 L_gp_7
L_gpd_8:
  s_mov_b64 exec, -1
  v_mov_b32 v24, v20
  s_nop 1
  v_max_f32_dpp v24, v24, v24 quad_perm:[1,0,3,2] row_mask:0xf bank_mask:0xf
  s_nop 1
  v_max_f32_dpp v24, v24, v24 quad_perm:[2,3,0,1] row_mask:0xf bank_mask:0xf
  s_nop 1
  v_max_f32_dpp v24, v24, v24 row_half_mirror row_mask:0xf bank_mask:0xf
  s_nop 1
  v_max_f32_dpp v24, v24, v24 row_ror:8 row_mask:0xf bank_mask:0xf
  v_mov_b32 v25, v24
  s_nop 1
  v_permlane16_swap_b32 v24, v25
  v_max_f32 v24, v24, v25
  v_mov_b32 v25, v24
  s_nop 1
  v_permlane32_swap_b32 v24, v25
  v_max_f32 v24, v24, v25
  v_sub_f32 v20, v20, v24
  v_mul_f32 v20, s53, v20
  v_exp_f32 v20, v20
  s_nop 0
  v_mul_f32 v22, v22, v20
  s_nop 1
  v_add_f32_dpp v22, v22, v22 quad_perm:[1,0,3,2] row_mask:0xf bank_mask:0xf
  s_nop 1
  v_add_f32_dpp v22, v22, v22 quad_perm:[2,3,0,1] row_mask:0xf bank_mask:0xf
  s_nop 1
  v_add_f32_dpp v22, v22, v22 row_half_mirror row_mask:0xf bank_mask:0xf
  s_nop 1
  v_add_f32_dpp v22, v22, v22 row_ror:8 row_mask:0xf bank_mask:0xf
  v_mov_b32 v25, v22
  s_nop 1
  v_permlane16_swap_b32 v22, v25
  v_add_f32 v22, v22, v25
  v_mov_b32 v25, v22
  s_nop 1
  v_permlane32_swap_b32 v22, v25
  v_add_f32 v22, v22, v25
  v_rcp_f32 v22, v22
  s_nop 0
  v_mul_f32 v20, v20, v22
  v_lshlrev_b32 v28, 2, v3
  s_lshl_b32 s10, s7, 3
  s_lshl_b64 exec, 0xff, s10
  ds_write_b32 v28, v20 offset:31360
  s_mov_b64 exec, -1
L_k_nostat:
  v_mov_b32 v28, 0
  s_mov_b32 s55, 0
L_lp_9:
  ds_read_b32 v29, v28 offset:31280
  s_waitcnt lgkmcnt(0)
  v_cmp_ne_u32 vcc, 8, v29
  s_cbranch_vccz L_lpd_10
  s_sleep 1
  s_add_u32 s55, s55, 1
  s_cmp_lt_u32 s55, 16777216
  s_cbranch_scc1 L_lp_9
L_lpd_10:
  s_cmp_lt_u32 s5, 30
  s_cbranch_scc0 L_nowo_ld
  global_load_dwordx4 v[32:35], v70, s[56:57] offset:0 nt
  global_load_dwordx4 v[36:39], v70, s[56:57] offset:1280 nt
  global_load_dwordx4 v[40:43], v70, s[56:57] offset:2560 nt
  global_load_dwordx4 v[44:47], v70, s[56:57] offset:3840 nt
L_nowo_ld:
  s_setprio 3
  s_waitcnt lgkmcnt(0)
  s_barrier
  ds_read_b128 v[96:99], v92 offset:8192
  ds_read_b128 v[28:31], v92 offset:8960
  ds_read_b32 v22, v93 offset:31360
  s_waitcnt lgkmcnt(0)
  v_pk_add_f32 v[96:97], v[96:97], v[28:29]
  v_pk_add_f32 v[98:99], v[98:99], v[30:31]
  v_pk_mul_f32 v[96:97], v[96:97], v[22:23] op_sel_hi:[1,0]
  v_pk_mul_f32 v[98:99], v[98:99], v[22:23] op_sel_hi:[1,0]
  s_nop 0
  v_add_f32_dpp v96, v96, v96 quad_perm:[1,0,3,2] row_mask:0xf bank_mask:0xf
  v_add_f32_dpp v97, v97, v97 quad_perm:[1,0,3,2] row_mask:0xf bank_mask:0xf
  v_add_f32_dpp v98, v98, v98 quad_perm:[1,0,3,2] row_mask:0xf bank_mask:0xf
  v_add_f32_dpp v99, v99, v99 quad_perm:[1,0,3,2] row_mask:0xf bank_mask:0xf
  v_add_f32_dpp v96, v96, v96 quad_perm:[2,3,0,1] row_mask:0xf bank_mask:0xf
  v_add_f32_dpp v97, v97, v97 quad_perm:[2,3,0,1] row_mask:0xf bank_mask:0xf
  v_add_f32_dpp v98, v98, v98 quad_perm:[2,3,0,1] row_mask:0xf bank_mask:0xf
  v_add_f32_dpp v99, v99, v99 quad_perm:[2,3,0,1] row_mask:0xf bank_mask:0xf
  v_add_f32_dpp v96, v96, v96 row_half_mirror row_mask:0xf bank_mask:0xf
  v_add_f32_dpp v97, v97, v97 row_half_mirror row_mask:0xf bank_mask:0xf
  v_add_f32_dpp v98, v98, v98 row_half_mirror row_mask:0xf bank_mask:0xf
  v_add_f32_dpp v99, v99, v99 row_half_mirror row_mask:0xf bank_mask:0xf
  v_perm_b32 v96, v96, v65, s45
  v_perm_b32 v97, v97, v65, s46
  v_perm_b32 v98, v98, v65, s47
  v_perm_b32 v99, v99, v65, s48
  s_mov_b32 exec_lo, 0x1010101
  s_mov_b32 exec_hi, 0x101
  s_cmp_eq_u32 s66, 1
  s_cbranch_scc0 L_ls_11
  global_store_dwordx4 v94, v[96:99], s[42:43]
  s_branch L_lsd_12
L_ls_11:
  global_store_dwordx4 v94, v[96:99], s[42:43] sc1
L_lsd_12:
  s_mov_b64 exec, -1
  s_cmp_lt_u32 s5, 30
  s_cbranch_scc0 L_nobar3
  global_load_dwordx4 v[16:19], v88, s[42:43] sc1
  s_mov_b32 s55, 0
L_pp_13:
  s_waitcnt vmcnt(0)
  v_xor_b32 v8, s49, v16
  v_xor_b32 v9, s50, v17
  v_xor_b32 v10, s51, v18
  v_xor_b32 v11, s60, v19
  v_or3_b32 v12, v8, v9, v10
  v_or_b32 v12, v12, v11
  v_and_b32 v12, 0xff, v12
  v_cmp_ne_u32 vcc, 0, v12
  s_cbranch_vccz L_ppd_14
  s_mov_b64 exec, vcc
  global_load_dwordx4 v[16:19], v88, s[42:43] sc1
  s_add_u32 s55, s55, 1
  s_cmp_lt_u32 s55, 1500000
  s_cbranch_scc1 L_pp_13
L_ppd_14:
  s_mov_b64 exec, -1
  v_add_f32_dpp v8, v8, v8 row_half_mirror row_mask:0xf bank_mask:0x5
  v_add_f32_dpp v9, v9, v9 row_half_mirror row_mask:0xf bank_mask:0x5
  s_nop 0
  v_add_f32_dpp v8, v10, v10 row_half_mirror row_mask:0xf bank_mask:0xa
  v_add_f32_dpp v9, v11, v11 row_half_mirror row_mask:0xf bank_mask:0xa
  s_nop 0
  v_add_f32_dpp v8, v8, v8 quad_perm:[1,0,3,2] row_mask:0xf bank_mask:0xf
  v_add_f32_dpp v9, v9, v9 quad_perm:[1,0,3,2] row_mask:0xf bank_mask:0xf
  s_nop 0
  v_add_f32_dpp v8, v8, v8 quad_perm:[2,3,0,1] row_mask:0xf bank_mask:0xf
  v_add_f32_dpp v9, v9, v9 quad_perm:[2,3,0,1] row_mask:0xf bank_mask:0xf
  v_cvt_pk_bf16_f32 v8, v8, v8
  v_cvt_pk_bf16_f32 v9, v9, v9
  v_and_b32 v24, v8, v4
  v_and_b32 v25, v8, v5
  v_and_b32_dpp v26, v8, v6 row_half_mirror row_mask:0xf bank_mask:0xf
  v_and_b32_dpp v27, v8, v7 row_half_mirror row_mask:0xf bank_mask:0xf
  v_and_b32 v28, v9, v4
  v_and_b32 v29, v9, v5
  v_and_b32_dpp v30, v9, v6 row_half_mirror row_mask:0xf bank_mask:0xf
  v_and_b32_dpp v31, v9, v7 row_half_mirror row_mask:0xf bank_mask:0xf
  v_mfma_f32_16x16x32_bf16 v[20:23], v[24:27], v[32:35], 0
  v_and_b32_dpp v24, v8, v4 row_half_mirror row_mask:0xf bank_mask:0xf
  v_and_b32_dpp v25, v8, v5 row_half_mirror row_mask:0xf bank_mask:0xf
  v_and_b32 v26, v8, v6
  v_and_b32 v27, v8, v7
  v_mfma_f32_16x16x32_bf16 v[20:23], v[28:31], v[36:39], v[20:23]
  v_and_b32_dpp v28, v9, v4 row_half_mirror row_mask:0xf bank_mask:0xf
  v_and_b32_dpp v29, v9, v5 row_half_mirror row_mask:0xf bank_mask:0xf
  v_and_b32 v30, v9, v6
  v_and_b32 v31, v9, v7
  v_mfma_f32_16x16x32_bf16 v[20:23], v[24:27], v[40:43], v[20:23]
  s_nop 0
  v_mfma_f32_16x16x32_bf16 v[20:23], v[28:31], v[44:47], v[20:23]
  s_mov_b32 exec_lo, 0xff00ff
  s_mov_b32 exec_hi, 0xff00ff00
  s_nop 5
  ds_write_b128 v89, v[20:23] offset:0
  s_mov_b64 exec, -1
  s_waitcnt lgkmcnt(0)
  s_barrier
  s_cmp_lt_u32 s9, 6
  s_cbranch_scc1 L_after_wo
  ds_read_b128 v[24:27], v90 offset:0
  ds_read_b128 v[28:31], v90 offset:256
  s_waitcnt lgkmcnt(0)
  v_pk_add_f32 v[24:25], v[24:25], v[28:29]
  v_pk_add_f32 v[26:27], v[26:27], v[30:31]
  s_nop 0
  v_add_f32_dpp v24, v24, v24 quad_perm:[1,0,3,2] row_mask:0xf bank_mask:0xf
  v_add_f32_dpp v25, v25, v25 quad_perm:[1,0,3,2] row_mask:0xf bank_mask:0xf
  v_add_f32_dpp v26, v26, v26 quad_perm:[1,0,3,2] row_mask:0xf bank_mask:0xf
  v_add_f32_dpp v27, v27, v27 quad_perm:[1,0,3,2] row_mask:0xf bank_mask:0xf
  v_add_f32_dpp v24, v24, v24 quad_perm:[2,3,0,1] row_mask:0xf bank_mask:0xf
  v_add_f32_dpp v25, v25, v25 quad_perm:[2,3,0,1] row_mask:0xf bank_mask:0xf
  v_add_f32_dpp v26, v26, v26 quad_perm:[2,3,0,1] row_mask:0xf bank_mask:0xf
  v_add_f32_dpp v27, v27, v27 quad_perm:[2,3,0,1] row_mask:0xf bank_mask:0xf
  v_add_f32_dpp v24, v24, v24 row_half_mirror row_mask:0xf bank_mask:0xf
  v_add_f32_dpp v25, v25, v25 row_half_mirror row_mask:0xf bank_mask:0xf
  v_add_f32_dpp v26, v26, v26 row_half_mirror row_mask:0xf bank_mask:0xf
  v_add_f32_dpp v27, v27, v27 row_half_mirror row_mask:0xf bank_mask:0xf
  v_perm_b32 v24, v24, v65, s45
  v_perm_b32 v25, v25, v65, s46
  v_perm_b32 v26, v26, v65, s47
  v_perm_b32 v27, v27, v65, s48
  s_mov_b32 exec_lo, 0x1010101
  s_mov_b32 exec_hi, 0x1010101
  global_store_dwordx4 v91, v[24:27], s[42:43] sc1
  s_mov_b64 exec, -1
L_after_wo:
  s_barrier
L_nobar3:
  s_cmp_lt_u32 s5, 20
  s_cselect_b32 s10, 6, 5
  s_cmp_lt_u32 s9, s10
  s_cbranch_scc0 L_nogd
  global_load_dwordx4 v[48:51], v66, s[58:59] nt
  global_load_dwordx4 v[52:55], v67, s[58:59] nt
  global_load_dwordx4 v[56:59], v68, s[58:59] nt
  global_load_dwordx4 v[60:63], v69, s[58:59] nt
L_nogd:
  s_cmp_lt_u32 s5, 20
  s_cbranch_scc0 L_d
  ds_read_b128 v[100:103], v95 offset:54272
  s_cmp_eq_u32 s9, 6
  s_cbranch_scc1 L_g_poll
  s_cmp_eq_u32 s9, 7
  s_cbranch_scc1 L_end
  s_waitcnt lgkmcnt(0)
  v_cvt_pk_bf16_f32 v8, v101, v101
  v_cvt_pk_bf16_f32 v9, v102, v102
  s_nop 0
  v_mov_b32_dpp v104, v8 row_newbcast:0 row_mask:0xf bank_mask:0x3
  v_mov_b32_dpp v105, v8 row_newbcast:2 row_mask:0xf bank_mask:0x3
  v_mov_b32_dpp v106, v8 row_newbcast:4 row_mask:0xf bank_mask:0x3
  v_mov_b32_dpp v107, v8 row_newbcast:6 row_mask:0xf bank_mask:0x3
  v_mov_b32_dpp v104, v8 row_newbcast:1 row_mask:0xf bank_mask:0xc
  v_mov_b32_dpp v105, v8 row_newbcast:3 row_mask:0xf bank_mask:0xc
  v_mov_b32_dpp v106, v8 row_newbcast:5 row_mask:0xf bank_mask:0xc
  v_mov_b32_dpp v107, v8 row_newbcast:7 row_mask:0xf bank_mask:0xc
  v_mov_b32_dpp v108, v9 row_newbcast:0 row_mask:0xf bank_mask:0x3
  v_mov_b32_dpp v109, v9 row_newbcast:2 row_mask:0xf bank_mask:0x3
  v_mov_b32_dpp v110, v9 row_newbcast:4 row_mask:0xf bank_mask:0x3
  v_mov_b32_dpp v111, v9 row_newbcast:6 row_mask:0xf bank_mask:0x3
  v_mov_b32_dpp v108, v9 row_newbcast:1 row_mask:0xf bank_mask:0xc
  v_mov_b32_dpp v109, v9 row_newbcast:3 row_mask:0xf bank_mask:0xc
  v_mov_b32_dpp v110, v9 row_newbcast:5 row_mask:0xf bank_mask:0xc
  v_mov_b32_dpp v111, v9 row_newbcast:7 row_mask:0xf bank_mask:0xc
  v_and_b32 v32, v104, v4
  v_and_b32 v33, v104, v5
  v_and_b32 v34, v104, v6
  v_and_b32 v35, v104, v7
  v_and_b32 v36, v105, v4
  v_and_b32 v37, v105, v5
  v_and_b32 v38, v105, v6
  v_and_b32 v39, v105, v7
  v_and_b32 v40, v106, v4
  v_and_b32 v41, v106, v5
  v_and_b32 v42, v106, v6
  v_and_b32 v43, v106, v7
  v_and_b32 v44, v107, v4
  v_and_b32 v45, v107, v5
  v_and_b32 v46, v107, v6
  v_and_b32 v47, v107, v7
  v_and_b32 v112, v108, v4
  v_and_b32 v113, v108, v5
  v_and_b32 v114, v108, v6
  v_and_b32 v115, v108, v7
  v_and_b32 v116, v109, v4
  v_and_b32 v117, v109, v5
  v_and_b32 v118, v109, v6
  v_and_b32 v119, v109, v7
  v_and_b32 v120, v110, v4
  v_and_b32 v121, v110, v5
  v_and_b32 v122, v110, v6
  v_and_b32 v123, v110, v7
  v_and_b32 v124, v111, v4
  v_and_b32 v125, v111, v5
  v_and_b32 v126, v111, v6
  v_and_b32 v127, v111, v7
  s_waitcnt vmcnt(0)
  v_mfma_f32_16x16x32_bf16 v[16:19], v[32:35], v[48:51], 0
  v_mfma_f32_16x16x32_bf16 v[20:23], v[112:115], v[48:51], 0
  v_mfma_f32_16x16x32_bf16 v[16:19], v[36:39], v[52:55], v[16:19]
  v_mfma_f32_16x16x32_bf16 v[20:23], v[116:119], v[52:55], v[20:23]
  v_mfma_f32_16x16x32_bf16 v[16:19], v[40:43], v[56:59], v[16:19]
  v_mfma_f32_16x16x32_bf16 v[20:23], v[120:123], v[56:59], v[20:23]
  v_mfma_f32_16x16x32_bf16 v[16:19], v[44:47], v[60:63], v[16:19]
  v_mfma_f32_16x16x32_bf16 v[20:23], v[124:127], v[60:63], v[20:23]
  s_nop 7
  v_permlane32_swap_b32 v16, v20
  v_permlane32_swap_b32 v17, v21
  v_permlane32_swap_b32 v18, v22
  v_permlane32_swap_b32 v19, v23
  v_add_f32_dpp v16, v20, v16 row_ror:8 row_mask:0xf bank_mask:0xf
  v_add_f32_dpp v17, v21, v17 row_ror:8 row_mask:0xf bank_mask:0xf
  v_add_f32_dpp v18, v22, v18 row_ror:8 row_mask:0xf bank_mask:0xf
  v_add_f32_dpp v19, v23, v19 row_ror:8 row_mask:0xf bank_mask:0xf
  v_perm_b32 v16, v16, v65, s45
  v_perm_b32 v17, v17, v65, s46
  v_perm_b32 v18, v18, v65, s47
  v_perm_b32 v19, v19, v65, s48
  s_mov_b32 exec_lo, 0xff00ff
  s_mov_b32 exec_hi, 0xff00ff
  s_cmp_eq_u32 s66, 1
  s_cbranch_scc0 L_ls_15
  global_store_dwordx4 v86, v[16:19], s[42:43]
  s_branch L_lsd_16
L_ls_15:
  global_store_dwordx4 v86, v[16:19], s[42:43] sc1
L_lsd_16:
  s_mov_b64 exec, -1
  s_barrier
  ds_read_b128 v[104:107], v73 offset:55552
  s_waitcnt lgkmcnt(0)
  v_and_b32 v24, v104, v4
  v_and_b32 v25, v104, v5
  v_and_b32 v26, v104, v6
  v_and_b32 v27, v104, v7
  v_and_b32 v28, v105, v4
  v_and_b32 v29, v105, v5
  v_and_b32 v30, v105, v6
  v_and_b32 v31, v105, v7
  v_mfma_f32_16x16x32_bf16 v[8:11], v[24:27], v[48:51], 0
  v_and_b32 v24, v106, v4
  v_and_b32 v25, v106, v5
  v_and_b32 v26, v106, v6
  v_and_b32 v27, v106, v7
  v_mfma_f32_16x16x32_bf16 v[8:11], v[28:31], v[52:55], v[8:11]
  v_and_b32 v28, v107, v4
  v_and_b32 v29, v107, v5
  v_and_b32 v30, v107, v6
  v_and_b32 v31, v107, v7
  v_mfma_f32_16x16x32_bf16 v[8:11], v[24:27], v[56:59], v[8:11]
  s_nop 0
  v_mfma_f32_16x16x32_bf16 v[8:11], v[28:31], v[60:63], v[8:11]
  s_nop 7
  v_permlane32_swap_b32 v8, v12
  v_permlane32_swap_b32 v9, v13
  v_permlane32_swap_b32 v10, v14
  v_permlane32_swap_b32 v11, v15
  v_add_f32_dpp v8, v12, v8 row_ror:8 row_mask:0xf bank_mask:0xf
  v_add_f32_dpp v9, v13, v9 row_ror:8 row_mask:0xf bank_mask:0xf
  v_add_f32_dpp v10, v14, v10 row_ror:8 row_mask:0xf bank_mask:0xf
  v_add_f32_dpp v11, v15, v11 row_ror:8 row_mask:0xf bank_mask:0xf
  v_perm_b32 v8, v8, v65, s45
  v_perm_b32 v9, v9, v65, s46
  v_perm_b32 v10, v10, v65, s47
  v_perm_b32 v11, v11, v65, s48
  s_mov_b32 exec_lo, 0xff00ff
  s_mov_b32 exec_hi, 0x0
  s_cmp_eq_u32 s66, 1
  s_cbranch_scc0 L_ls_17
  global_store_dwordx4 v85, v[8:11], s[42:43]
  s_branch L_lsd_18
L_ls_17:
  global_store_dwordx4 v85, v[8:11], s[42:43] sc1
L_lsd_18:
  s_mov_b64 exec, -1
  s_branch L_fin
L_g_poll:
  s_waitcnt vmcnt(0)
  global_load_dwordx4 v[8:11], v82, s[42:43] sc1
  global_load_dwordx4 v[12:15], v83, s[42:43] sc1
  global_load_dwordx4 v[16:19], v84, s[42:43] sc1
  global_load_dwordx4 v[20:23], v82, s[42:43] sc1
  global_load_dwordx4 v[24:27], v83, s[42:43] sc1
  global_load_dwordx4 v[28:31], v84, s[42:43] sc1
  s_mov_b32 s55, 0
L_pp_19:
  s_waitcnt vmcnt(3)
  v_xor_b32 v32, s49, v8
  v_xor_b32 v33, s50, v9
  v_xor_b32 v34, s51, v10
  v_xor_b32 v35, s60, v11
  v_xor_b32 v36, s49, v12
  v_xor_b32 v37, s50, v13
  v_xor_b32 v38, s51, v14
  v_xor_b32 v39, s60, v15
  v_xor_b32 v40, s49, v16
  v_xor_b32 v41, s50, v17
  v_xor_b32 v42, s51, v18
  v_xor_b32 v43, s60, v19
  v_or3_b32 v56, v32, v33, v34
  v_or3_b32 v56, v56, v35, v36
  v_or3_b32 v56, v56, v37, v38
  v_or3_b32 v56, v56, v39, v40
  v_or3_b32 v56, v56, v41, v42
  v_or_b32 v56, v56, v43
  v_and_b32 v56, 0xff, v56
  v_cmp_ne_u32 vcc, 0, v56
  s_cbranch_vccz L_ppd_20
  s_mov_b64 exec, vcc
  global_load_dwordx4 v[8:11], v82, s[42:43] sc1
  global_load_dwordx4 v[12:15], v83, s[42:43] sc1
  global_load_dwordx4 v[16:19], v84, s[42:43] sc1
  s_waitcnt vmcnt(3)
  v_xor_b32 v32, s49, v20
  v_xor_b32 v33, s50, v21
  v_xor_b32 v34, s51, v22
  v_xor_b32 v35, s60, v23
  v_xor_b32 v36, s49, v24
  v_xor_b32 v37, s50, v25
  v_xor_b32 v38, s51, v26
  v_xor_b32 v39, s60, v27
  v_xor_b32 v40, s49, v28
  v_xor_b32 v41, s50, v29
  v_xor_b32 v42, s51, v30
  v_xor_b32 v43, s60, v31
  v_or3_b32 v56, v32, v33, v34
  v_or3_b32 v56, v56, v35, v36
  v_or3_b32 v56, v56, v37, v38
  v_or3_b32 v56, v56, v39, v40
  v_or3_b32 v56, v56, v41, v42
  v_or_b32 v56, v56, v43
  v_and_b32 v56, 0xff, v56
  v_cmp_ne_u32 vcc, 0, v56
  s_cbranch_vccz L_ppd_20
  s_mov_b64 exec, vcc
  global_load_dwordx4 v[20:23], v82, s[42:43] sc1
  global_load_dwordx4 v[24:27], v83, s[42:43] sc1
  global_load_dwordx4 v[28:31], v84, s[42:43] sc1
  s_add_u32 s55, s55, 1
  s_cmp_lt_u32 s55, 1500000
  s_cbranch_scc1 L_pp_19
L_ppd_20:
  s_mov_b64 exec, -1
  s_waitcnt lgkmcnt(0)
  v_pk_add_f32 v[32:33], v[32:33], v[36:37]
  v_pk_add_f32 v[34:35], v[34:35], v[38:39]
  v_pk_add_f32 v[32:33], v[32:33], v[40:41]
  v_pk_add_f32 v[34:35], v[34:35], v[42:43]
  s_nop 1
  v_permlane32_swap_b32 v32, v34
  v_permlane32_swap_b32 v33, v35
  v_add_f32 v32, v32, v34
  v_add_f32 v33, v33, v35
  s_nop 1
  v_permlane16_swap_b32 v32, v33
  v_add_f32 v32, v32, v33
  s_nop 1
  v_add_f32_dpp v32, v32, v32 row_ror:8 row_mask:0xf bank_mask:0xf
  v_fma_f32 v32, v32, v100, v103
  v_mul_f32 v33, v32, v101
  v_cvt_pk_bf16_f32 v33, v33, v33
  ds_write_b32 v72, v33 offset:55552
  v_mul_f32 v34, v32, v32
  v_lshlrev_b32 v58, 2, v1
  ds_write_b32 v58, v32 offset:56320
  s_waitcnt lgkmcnt(0)
  s_barrier
  v_add_f32_dpp v32, v32, v32 quad_perm:[1,0,3,2] row_mask:0xf bank_mask:0xf
  v_add_f32_dpp v34, v34, v34 quad_perm:[1,0,3,2] row_mask:0xf bank_mask:0xf
  s_nop 0
  v_add_f32_dpp v32, v32, v32 quad_perm:[2,3,0,1] row_mask:0xf bank_mask:0xf
  v_add_f32_dpp v34, v34, v34 quad_perm:[2,3,0,1] row_mask:0xf bank_mask:0xf
  s_nop 0
  v_add_f32_dpp v32, v32, v32 row_half_mirror row_mask:0xf bank_mask:0xf
  v_add_f32_dpp v34, v34, v34 row_half_mirror row_mask:0xf bank_mask:0xf
  v_mov_b32 v36, v32
  v_mov_b32 v37, v34
  s_nop 0
  v_permlane16_swap_b32 v32, v36
  v_permlane16_swap_b32 v34, v37
  v_add_f32 v32, v32, v36
  v_add_f32 v34, v34, v37
  v_mov_b32 v36, v32
  v_mov_b32 v37, v34
  s_nop 0
  v_permlane32_swap_b32 v32, v36
  v_permlane32_swap_b32 v34, v37
  v_add_f32 v32, v32, v36
  v_add_f32 v34, v34, v37
  v_mov_b32 v33, s44
  v_mov_b32 v35, s44
  s_mov_b32 exec_lo, 0xfff
  s_mov_b32 exec_hi, 0x0
  s_cmp_eq_u32 s66, 1
  s_cbranch_scc0 L_ls_21
  global_store_dwordx4 v87, v[32:35], s[42:43]
  s_branch L_lsd_22
L_ls_21:
  global_store_dwordx4 v87, v[32:35], s[42:43] sc1
L_lsd_22:
  s_mov_b64 exec, -1
L_fin:
  s_cmp_eq_u32 s7, s4
  s_cbranch_scc0 L_end
  s_cmp_lt_u32 s9, 4
  s_cbranch_scc0 L_end
  ds_read_b32 v58, v76 offset:56320
  ds_read_b32 v59, v76 offset:55296
  s_waitcnt vmcnt(0) lgkmcnt(0)
  s_barrier
  global_load_dwordx4 v[8:11], v77, s[42:43] sc1
  global_load_dwordx4 v[12:15], v78, s[42:43] sc1
  global_load_dwordx4 v[16:19], v79, s[42:43] sc1
  s_mov_b32 s55, 0
L_pp_23:
  s_waitcnt vmcnt(0)
  v_xor_b32 v32, s49, v8
  v_xor_b32 v33, s50, v9
  v_xor_b32 v34, s51, v10
  v_xor_b32 v35, s60, v11
  v_xor_b32 v36, s49, v12
  v_xor_b32 v37, s50, v13
  v_xor_b32 v38, s51, v14
  v_xor_b32 v39, s60, v15
  v_xor_b32 v40, s49, v16
  v_xor_b32 v41, s50, v17
  v_xor_b32 v42, s51, v18
  v_xor_b32 v43, s60, v19
  v_or3_b32 v56, v32, v33, v34
  v_or3_b32 v56, v56, v35, v36
  v_or3_b32 v56, v56, v37, v38
  v_or3_b32 v56, v56, v39, v40
  v_or3_b32 v56, v56, v41, v42
  v_or_b32 v56, v56, v43
  v_and_b32 v56, 0xff, v56
  v_cmp_ne_u32 vcc, 0, v56
  s_cbranch_vccz L_ppd_24
  s_mov_b64 exec, vcc
  global_load_dwordx4 v[8:11], v77, s[42:43] sc1
  global_load_dwordx4 v[12:15], v78, s[42:43] sc1
  global_load_dwordx4 v[16:19], v79, s[42:43] sc1
  s_add_u32 s55, s55, 1
  s_cmp_lt_u32 s55, 1500000
  s_cbranch_scc1 L_pp_23
L_ppd_24:
  s_mov_b64 exec, -1
  v_pk_add_f32 v[32:33], v[32:33], v[36:37]
  v_pk_add_f32 v[34:35], v[34:35], v[38:39]
  v_pk_add_f32 v[32:33], v[32:33], v[40:41]
  v_pk_add_f32 v[34:35], v[34:35], v[42:43]
  s_nop 1
  v_permlane32_swap_b32 v32, v34
  v_permlane32_swap_b32 v33, v35
  v_add_f32 v32, v32, v34
  v_add_f32 v33, v33, v35
  s_nop 1
  v_permlane16_swap_b32 v32, v33
  v_add_f32 v32, v32, v33
  s_nop 1
  v_add_f32_dpp v32, v32, v32 row_ror:8 row_mask:0xf bank_mask:0xf
  s_nop 1
  v_add_f32_dpp v32, v32, v32 row_ror:4 row_mask:0xf bank_mask:0xf
  s_nop 1
  v_add_f32_dpp v32, v32, v32 quad_perm:[2,3,0,1] row_mask:0xf bank_mask:0xf
  v_fma_f32 v32, v32, v59, v58
  v_cvt_pk_bf16_f32 v32, v32, v32
  s_mov_b32 exec_lo, 0x30003
  s_mov_b32 exec_hi, 0x30003
  global_store_short v75, v32, s[38:39]
  s_cmp_lg_u32 s12, 0
  s_cbranch_scc1 L_fin_done
  s_mov_b32 exec_lo, 0x1
  s_mov_b32 exec_hi, 0x0
  v_mov_b32 v60, 0
  global_store_dword v60, v65, s[42:43]
L_fin_done:
  s_mov_b64 exec, -1
  s_branch L_end
L_d:
  s_cmp_lt_u32 s9, 5
  s_cbranch_scc0 L_d_poll
  s_waitcnt vmcnt(0)
  s_barrier
  s_barrier
  ds_read_b128 v[104:107], v73 offset:55552
  s_waitcnt lgkmcnt(0)
  v_and_b32 v24, v104, v4
  v_and_b32 v25, v104, v5
  v_and_b32 v26, v104, v6
  v_and_b32 v27, v104, v7
  v_and_b32 v28, v105, v4
  v_and_b32 v29, v105, v5
  v_and_b32 v30, v105, v6
  v_and_b32 v31, v105, v7
  v_mfma_f32_16x16x32_bf16 v[8:11], v[24:27], v[48:51], 0
  v_and_b32 v24, v106, v4
  v_and_b32 v25, v106, v5
  v_and_b32 v26, v106, v6
  v_and_b32 v27, v106, v7
  v_mfma_f32_16x16x32_bf16 v[8:11], v[28:31], v[52:55], v[8:11]
  v_and_b32 v28, v107, v4
  v_and_b32 v29, v107, v5
  v_and_b32 v30, v107, v6
  v_and_b32 v31, v107, v7
  v_mfma_f32_16x16x32_bf16 v[8:11], v[24:27], v[56:59], v[8:11]
  s_nop 0
  v_mfma_f32_16x16x32_bf16 v[8:11], v[28:31], v[60:63], v[8:11]
  s_nop 7
  v_perm_b32 v8, v8, v65, s45
  v_perm_b32 v9, v9, v65, s46
  v_perm_b32 v10, v10, v65, s47
  v_perm_b32 v11, v11, v65, s48
  s_mov_b32 exec_lo, 0xffffffff
  s_mov_b32 exec_hi, 0x0
  global_store_dwordx4 v85, v[8:11], s[42:43] sc1
  s_mov_b64 exec, -1
  s_branch L_end
L_d_poll:
  s_sub_u32 s10, s9, 5
  s_mul_i32 s11, s10, 36864
  v_add_u32 v82, s11, v82
  v_add_u32 v83, s11, v83
  v_add_u32 v84, s11, v84
  s_waitcnt vmcnt(0)
  v_mov_b32 v24, s49
  v_mov_b32 v25, s50
  v_mov_b32 v26, s51
  v_mov_b32 v27, s60
  s_mov_b32 exec_lo, 0x0
  s_mov_b32 exec_hi, 0xffffffff
  s_cmp_eq_u32 s66, 1
  s_cbranch_scc0 L_ls_25
  global_store_dwordx4 v84, v[24:27], s[42:43]
  s_branch L_lsd_26
L_ls_25:
  global_store_dwordx4 v84, v[24:27], s[42:43] sc1
L_lsd_26:
  s_mov_b64 exec, -1
  s_cmp_eq_u32 s9, 5
  s_cbranch_scc1 L_d_main
  s_lshl_b32 s10, s9, 2
  v_lshl_add_u32 v58, v1, 3, s10
  global_load_dwordx4 v[112:115], v82, s[42:43] sc1
  global_load_dwordx4 v[116:119], v83, s[42:43] sc1
  global_load_dwordx4 v[120:123], v84, s[42:43] sc1
  s_mov_b32 s55, 0
L_pp_27:
  s_waitcnt vmcnt(0)
  v_xor_b32 v8, s49, v112
  v_xor_b32 v9, s50, v113
  v_xor_b32 v10, s51, v114
  v_xor_b32 v11, s60, v115
  v_xor_b32 v12, s49, v116
  v_xor_b32 v13, s50, v117
  v_xor_b32 v14, s51, v118
  v_xor_b32 v15, s60, v119
  v_xor_b32 v16, s49, v120
  v_xor_b32 v17, s50, v121
  v_xor_b32 v18, s51, v122
  v_xor_b32 v19, s60, v123
  v_or3_b32 v60, v8, v9, v10
  v_or3_b32 v60, v60, v11, v12
  v_or3_b32 v60, v60, v13, v14
  v_or3_b32 v60, v60, v15, v16
  v_or3_b32 v60, v60, v17, v18
  v_or_b32 v60, v60, v19
  v_and_b32 v60, 0xff, v60
  v_cmp_ne_u32 vcc, 0, v60
  s_cbranch_vccz L_ppd_28
  s_mov_b64 exec, vcc
  global_load_dwordx4 v[112:115], v82, s[42:43] sc1
  global_load_dwordx4 v[116:119], v83, s[42:43] sc1
  global_load_dwordx4 v[120:123], v84, s[42:43] sc1
  s_add_u32 s55, s55, 1
  s_cmp_lt_u32 s55, 1500000
  s_cbranch_scc1 L_pp_27
L_ppd_28:
  s_mov_b64 exec, -1
  v_pk_add_f32 v[8:9], v[8:9], v[12:13]
  v_pk_add_f32 v[10:11], v[10:11], v[14:15]
  v_pk_add_f32 v[8:9], v[8:9], v[16:17]
  v_pk_add_f32 v[10:11], v[10:11], v[18:19]
  s_nop 1
  v_permlane32_swap_b32 v8, v10
  v_permlane32_swap_b32 v9, v11
  v_add_f32 v8, v8, v10
  v_add_f32 v9, v9, v11
  s_nop 1
  v_permlane16_swap_b32 v8, v9
  v_add_f32 v8, v8, v9
  s_nop 1
  v_add_f32_dpp v8, v8, v8 row_ror:8 row_mask:0xf bank_mask:0xf
  ds_write_b32 v58, v8 offset:56552
  s_waitcnt lgkmcnt(0)
  s_barrier
  s_branch L_end
L_d_main:
  v_mov_b32 v28, 0
  v_mov_b32 v29, s44
  v_mov_b32 v30, 0
  v_mov_b32 v31, s44
  s_mov_b32 exec_lo, 0x0
  s_mov_b32 exec_hi, 0xfff00000
  s_cmp_eq_u32 s66, 1
  s_cbranch_scc0 L_ls_29
  global_store_dwordx4 v87, v[28:31], s[42:43]
  s_branch L_lsd_30
L_ls_29:
  global_store_dwordx4 v87, v[28:31], s[42:43] sc1
L_lsd_30:
  s_mov_b64 exec, -1
  s_mov_b32 s10, 0x3d372713
  s_mov_b32 s11, 0x3acccccd
  v_mov_b32 v59, 0x3727c5ac
  v_lshlrev_b32 v58, 3, v1
  global_load_dwordx4 v[112:115], v82, s[42:43] sc1
  global_load_dwordx4 v[116:119], v83, s[42:43] sc1
  global_load_dwordx4 v[120:123], v84, s[42:43] sc1
  global_load_dwordx4 v[124:127], v87, s[42:43] sc1
  global_load_dwordx4 v[40:43], v82, s[42:43] sc1
  global_load_dwordx4 v[44:47], v83, s[42:43] sc1
  global_load_dwordx4 v[48:51], v84, s[42:43] sc1
  global_load_dwordx4 v[52:55], v87, s[42:43] sc1
  s_mov_b32 s55, 0
L_pp_31:
  s_waitcnt vmcnt(4)
  v_xor_b32 v8, s49, v112
  v_xor_b32 v9, s50, v113
  v_xor_b32 v10, s51, v114
  v_xor_b32 v11, s60, v115
  v_xor_b32 v12, s49, v116
  v_xor_b32 v13, s50, v117
  v_xor_b32 v14, s51, v118
  v_xor_b32 v15, s60, v119
  v_xor_b32 v16, s49, v120
  v_xor_b32 v17, s50, v121
  v_xor_b32 v18, s51, v122
  v_xor_b32 v19, s60, v123
  v_mov_b32 v20, v124
  v_xor_b32 v21, s44, v125
  v_mov_b32 v22, v126
  v_xor_b32 v23, s44, v127
  v_or3_b32 v60, v8, v9, v10
  v_or3_b32 v60, v60, v11, v12
  v_or3_b32 v60, v60, v13, v14
  v_or3_b32 v60, v60, v15, v16
  v_or3_b32 v60, v60, v17, v18
  v_or_b32 v60, v60, v19
  v_and_b32 v60, 0xff, v60
  v_or3_b32 v60, v60, v21, v23
  v_cmp_ne_u32 vcc, 0, v60
  s_cbranch_vccz L_ppd_32
  s_mov_b64 exec, vcc
  global_load_dwordx4 v[112:115], v82, s[42:43] sc1
  global_load_dwordx4 v[116:119], v83, s[42:43] sc1
  global_load_dwordx4 v[120:123], v84, s[42:43] sc1
  global_load_dwordx4 v[124:127], v87, s[42:43] sc1
  s_waitcnt vmcnt(4)
  v_xor_b32 v8, s49, v40
  v_xor_b32 v9, s50, v41
  v_xor_b32 v10, s51, v42
  v_xor_b32 v11, s60, v43
  v_xor_b32 v12, s49, v44
  v_xor_b32 v13, s50, v45
  v_xor_b32 v14, s51, v46
  v_xor_b32 v15, s60, v47
  v_xor_b32 v16, s49, v48
  v_xor_b32 v17, s50, v49
  v_xor_b32 v18, s51, v50
  v_xor_b32 v19, s60, v51
  v_mov_b32 v20, v52
  v_xor_b32 v21, s44, v53
  v_mov_b32 v22, v54
  v_xor_b32 v23, s44, v55
  v_or3_b32 v60, v8, v9, v10
  v_or3_b32 v60, v60, v11, v12
  v_or3_b32 v60, v60, v13, v14
  v_or3_b32 v60, v60, v15, v16
  v_or3_b32 v60, v60, v17, v18
  v_or_b32 v60, v60, v19
  v_and_b32 v60, 0xff, v60
  v_or3_b32 v60, v60, v21, v23
  v_cmp_ne_u32 vcc, 0, v60
  s_cbranch_vccz L_ppd_32
  s_mov_b64 exec, vcc
  global_load_dwordx4 v[40:43], v82, s[42:43] sc1
  global_load_dwordx4 v[44:47], v83, s[42:43] sc1
  global_load_dwordx4 v[48:51], v84, s[42:43] sc1
  global_load_dwordx4 v[52:55], v87, s[42:43] sc1
  s_add_u32 s55, s55, 1
  s_cmp_lt_u32 s55, 1500000
  s_cbranch_scc1 L_pp_31
L_ppd_32:
  s_mov_b64 exec, -1
  s_barrier
  ds_read_b64 v[56:57], v58 offset:56576
  v_add_f32_dpp v20, v20, v20 quad_perm:[1,0,3,2] row_mask:0xf bank_mask:0xf
  v_add_f32_dpp v22, v22, v22 quad_perm:[1,0,3,2] row_mask:0xf bank_mask:0xf
  v_pk_add_f32 v[8:9], v[8:9], v[12:13]
  v_pk_add_f32 v[10:11], v[10:11], v[14:15]
  v_add_f32_dpp v20, v20, v20 quad_perm:[2,3,0,1] row_mask:0xf bank_mask:0xf
  v_add_f32_dpp v22, v22, v22 quad_perm:[2,3,0,1] row_mask:0xf bank_mask:0xf
  v_pk_add_f32 v[8:9], v[8:9], v[16:17]
  v_pk_add_f32 v[10:11], v[10:11], v[18:19]
  v_add_f32_dpp v20, v20, v20 row_half_mirror row_mask:0xf bank_mask:0xf
  v_add_f32_dpp v22, v22, v22 row_half_mirror row_mask:0xf bank_mask:0xf
  v_permlane32_swap_b32 v8, v10
  v_permlane32_swap_b32 v9, v11
  v_add_f32_dpp v20, v20, v20 row_ror:8 row_mask:0xf bank_mask:0xf
  v_add_f32_dpp v22, v22, v22 row_ror:8 row_mask:0xf bank_mask:0xf
  v_add_f32 v8, v8, v10
  v_add_f32 v9, v9, v11
  v_mov_b32 v21, v20
  v_mov_b32 v23, v22
  v_permlane16_swap_b32 v8, v9
  v_permlane16_swap_b32 v20, v21
  v_permlane16_swap_b32 v22, v23
  v_add_f32 v8, v8, v9
  v_add_f32 v20, v20, v21
  v_add_f32 v22, v22, v23
  v_mul_f32 v20, s11, v20
  v_fma_f32 v22, v22, s11, v59
  v_add_f32_dpp v8, v8, v8 row_ror:8 row_mask:0xf bank_mask:0xf
  v_fma_f32 v22, -v20, v20, v22
  v_max_f32 v22, v22, v59
  v_rsq_f32 v58, v22
  s_waitcnt lgkmcnt(0)
  v_fma_f32 v8, -v20, v56, v8
  v_fma_f32 v8, v8, v58, v57
  v_mul_f32 v9, v8, v8
  v_mul_f32 v10, 0xc0135761, v8
  v_fma_f32 v9, v9, s10, 1.0
  v_mul_f32_dpp v11, v8, v8 row_shl:4 row_mask:0xf bank_mask:0xf
  v_mul_f32 v9, v9, v10
  v_exp_f32 v9, v9
  s_nop 0
  v_add_f32 v9, 1.0, v9
  v_rcp_f32 v9, v9
  s_mov_b32 exec_lo, 0xf000f
  s_mov_b32 exec_hi, 0xf000f
  v_mul_f32 v11, v11, v9
  v_cvt_pk_bf16_f32 v11, v11, v11
  ds_write_b32 v72, v11 offset:55552
  s_mov_b64 exec, -1
  s_waitcnt lgkmcnt(0)
  s_barrier
  s_branch L_end
L_kvgo_v:
  s_mov_b32 s55, 0
L_lp_33:
  ds_read_b32 v29, v9 offset:31312
  s_waitcnt lgkmcnt(0)
  v_cmp_ne_u32 vcc, 1, v29
  s_cbranch_vccz L_lpd_34
  s_sleep 1
  s_add_u32 s55, s55, 1
  s_cmp_lt_u32 s55, 16777216
  s_cbranch_scc1 L_lp_33
L_lpd_34:
  s_add_u32 s56, s20, s8
  s_addc_u32 s57, s21, 0
  s_setprio 3
  global_load_dwordx4 v[32:35], v12, s[56:57] offset:0 nt
  global_load_dwordx4 v[36:39], v12, s[56:57] offset:128 nt
  global_load_dwordx4 v[40:43], v12, s[56:57] offset:256 nt
  s_waitcnt vmcnt(2)
  global_load_dwordx4 v[44:47], v13, s[56:57] offset:0 nt
  s_waitcnt vmcnt(2)
  global_load_dwordx4 v[48:51], v13, s[56:57] offset:128 nt
  s_waitcnt vmcnt(2)
  global_load_dwordx4 v[52:55], v13, s[56:57] offset:256 nt
  s_waitcnt vmcnt(2)
  global_load_dwordx4 v[56:59], v14, s[56:57] offset:0 nt
  s_waitcnt vmcnt(2)
  global_load_dwordx4 v[60:63], v14, s[56:57] offset:128 nt
  s_waitcnt vmcnt(2)
  global_load_dwordx4 v[64:67], v14, s[56:57] offset:256 nt
  s_waitcnt vmcnt(2)
  global_load_dwordx4 v[68:71], v15, s[56:57] offset:0 nt
  s_waitcnt vmcnt(2)
  global_load_dwordx4 v[72:75], v15, s[56:57] offset:128 nt
  s_waitcnt vmcnt(2)
  global_load_dwordx4 v[76:79], v15, s[56:57] offset:256 nt
  s_waitcnt vmcnt(2)
  global_load_dwordx4 v[80:83], v16, s[56:57] offset:0 nt
  s_waitcnt vmcnt(2)
  global_load_dwordx4 v[84:87], v16, s[56:57] offset:128 nt
  s_waitcnt vmcnt(2)
  global_load_dwordx4 v[88:91], v16, s[56:57] offset:256 nt
  s_waitcnt vmcnt(2)
  global_load_dwordx4 v[92:95], v17, s[56:57] offset:0 nt
  s_waitcnt vmcnt(2)
  global_load_dwordx4 v[96:99], v17, s[56:57] offset:128 nt
  s_waitcnt vmcnt(2)
  global_load_dwordx4 v[100:103], v17, s[56:57] offset:256 nt
  s_waitcnt vmcnt(2)
  global_load_dwordx4 v[104:107], v18, s[56:57] offset:0 nt
  s_waitcnt vmcnt(2)
  global_load_dwordx4 v[108:111], v18, s[56:57] offset:128 nt
  s_waitcnt vmcnt(2)
  global_load_dwordx4 v[112:115], v18, s[56:57] offset:256 nt
  global_load_dwordx4 v[116:119], v19, s[56:57] offset:0 nt
  global_load_dwordx4 v[120:123], v19, s[56:57] offset:128 nt
  global_load_dwordx4 v[124:127], v19, s[56:57] offset:256 nt
  s_mov_b32 exec_lo, 0x1
  s_mov_b32 exec_hi, 0x0
  ds_add_u32 v11, v10 offset:31280
  s_mov_b64 exec, -1
  s_mul_i32 s10, s9, 1600
  v_lshl_add_u32 v0, v3, 5, s10
  v_and_b32 v28, 16, v1
  v_add_u32 v0, v0, v28
  v_lshrrev_b32 v28, 5, v1
  v_mul_u32_u24 v28, 768, v28
  v_add_u32 v0, v0, v28
  s_lshl_b32 s10, s9, 2
  v_mov_b32 v28, s10
  s_mov_b32 s55, 0
L_lp_35:
  ds_read_b32 v29, v28 offset:31248
  s_waitcnt lgkmcnt(0)
  v_cmp_ne_u32 vcc, 1, v29
  s_cbranch_vccz L_lpd_36
  s_sleep 1
  s_add_u32 s55, s55, 1
  s_cmp_lt_u32 s55, 16777216
  s_cbranch_scc1 L_lp_35
L_lpd_36:
  s_lshl_b32 s10, s9, 8
  v_lshl_add_u32 v28, v2, 5, s10
  ds_read_b128 v[8:11], v28 offset:31744
  ds_read_b128 v[12:15], v28 offset:31760
  s_waitcnt lgkmcnt(0)
  v_and_b32 v28, v8, v4
  v_and_b32 v29, v8, v5
  v_and_b32 v30, v8, v6
  v_and_b32 v31, v8, v7
  s_waitcnt vmcnt(21)
  s_nop 0
  v_mfma_f32_16x16x32_bf16 v[16:19], v[28:31], v[32:35], 0
  v_mfma_f32_16x16x32_bf16 v[20:23], v[28:31], v[36:39], 0
  v_mfma_f32_16x16x32_bf16 v[24:27], v[28:31], v[40:43], 0
  v_and_b32 v28, v9, v4
  v_and_b32 v29, v9, v5
  v_and_b32 v30, v9, v6
  v_and_b32 v31, v9, v7
  s_waitcnt vmcnt(18)
  s_nop 0
  v_mfma_f32_16x16x32_bf16 v[16:19], v[28:31], v[44:47], v[16:19]
  v_mfma_f32_16x16x32_bf16 v[20:23], v[28:31], v[48:51], v[20:23]
  v_mfma_f32_16x16x32_bf16 v[24:27], v[28:31], v[52:55], v[24:27]
  v_and_b32 v28, v10, v4
  v_and_b32 v29, v10, v5
  v_and_b32 v30, v10, v6
  v_and_b32 v31, v10, v7
  s_waitcnt vmcnt(15)
  s_nop 0
  v_mfma_f32_16x16x32_bf16 v[16:19], v[28:31], v[56:59], v[16:19]
  v_mfma_f32_16x16x32_bf16 v[20:23], v[28:31], v[60:63], v[20:23]
  v_mfma_f32_16x16x32_bf16 v[24:27], v[28:31], v[64:67], v[24:27]
  v_and_b32 v28, v11, v4
  v_and_b32 v29, v11, v5
  v_and_b32 v30, v11, v6
  v_and_b32 v31, v11, v7
  s_waitcnt vmcnt(12)
  s_nop 0
  v_mfma_f32_16x16x32_bf16 v[16:19], v[28:31], v[68:71], v[16:19]
  v_mfma_f32_16x16x32_bf16 v[20:23], v[28:31], v[72:75], v[20:23]
  v_mfma_f32_16x16x32_bf16 v[24:27], v[28:31], v[76:79], v[24:27]
  v_and_b32 v28, v12, v4
  v_and_b32 v29, v12, v5
  v_and_b32 v30, v12, v6
  v_and_b32 v31, v12, v7
  s_waitcnt vmcnt(9)
  s_nop 0
  v_mfma_f32_16x16x32_bf16 v[16:19], v[28:31], v[80:83], v[16:19]
  v_mfma_f32_16x16x32_bf16 v[20:23], v[28:31], v[84:87], v[20:23]
  v_mfma_f32_16x16x32_bf16 v[24:27], v[28:31], v[88:91], v[24:27]
  v_and_b32 v28, v13, v4
  v_and_b32 v29, v13, v5
  v_and_b32 v30, v13, v6
  v_and_b32 v31, v13, v7
  s_waitcnt vmcnt(6)
  s_nop 0
  v_mfma_f32_16x16x32_bf16 v[16:19], v[28:31], v[92:95], v[16:19]
  v_mfma_f32_16x16x32_bf16 v[20:23], v[28:31], v[96:99], v[20:23]
  v_mfma_f32_16x16x32_bf16 v[24:27], v[28:31], v[100:103], v[24:27]
  v_and_b32 v28, v14, v4
  v_and_b32 v29, v14, v5
  v_and_b32 v30, v14, v6
  v_and_b32 v31, v14, v7
  s_waitcnt vmcnt(3)
  s_nop 0
  v_mfma_f32_16x16x32_bf16 v[16:19], v[28:31], v[104:107], v[16:19]
  v_mfma_f32_16x16x32_bf16 v[20:23], v[28:31], v[108:111], v[20:23]
  v_mfma_f32_16x16x32_bf16 v[24:27], v[28:31], v[112:115], v[24:27]
  v_and_b32 v28, v15, v4
  v_and_b32 v29, v15, v5
  v_and_b32 v30, v15, v6
  v_and_b32 v31, v15, v7
  s_waitcnt vmcnt(0)
  s_nop 0
  v_mfma_f32_16x16x32_bf16 v[16:19], v[28:31], v[116:119], v[16:19]
  v_mfma_f32_16x16x32_bf16 v[20:23], v[28:31], v[120:123], v[20:23]
  v_mfma_f32_16x16x32_bf16 v[24:27], v[28:31], v[124:127], v[24:27]
  s_mov_b32 exec_lo, 0xff00ff
  s_mov_b32 exec_hi, 0xff00ff00
  s_nop 3
  ds_write_b128 v0, v[16:19] offset:8192
  ds_write_b128 v0, v[20:23] offset:8448
  ds_write_b128 v0, v[24:27] offset:8704
  s_mov_b64 exec, -1
  s_waitcnt lgkmcnt(0)
  s_barrier
  s_endpgm
L_early:
  s_setprio 3
  s_cmp_lt_u32 s9, 4
  s_cbranch_scc0 L_e_q
  s_and_b32 s12, s2, 3
  s_lshr_b32 s13, s2, 2
  s_mul_i32 s10, s12, 1228800
  s_lshl_b32 s11, s13, 7
  s_add_u32 s10, s10, s11
  s_mul_i32 s11, s9, 61440
  s_add_u32 s14, s10, s11
  v_mul_u32_u24 v16, 7680, v2
  v_lshl_add_u32 v16, v3, 4, v16
  v_add_u32 v17, 245760, v16
  v_add_u32 v18, 491520, v16
  v_add_u32 v19, 737280, v16
  v_add_u32 v20, 983040, v16
  s_lshl_b32 s61, s9, 10
  s_add_u32 s61, s61, 33792
  s_mul_i32 s10, s12, 320
  v_lshl_add_u32 v8, v1, 1, s10
  v_min_u32 v9, 31, v1
  v_lshl_add_u32 v9, v9, 1, s10
  s_waitcnt lgkmcnt(0)
  s_load_dword s44, s[42:43], 0
  s_add_u32 s56, s36, s14
  s_addc_u32 s57, s37, 0
  s_cmp_eq_u32 s9, 0
  s_cbranch_scc0 L_e_noc
  global_load_ushort v10, v8, s[34:35]
  global_load_ushort v11, v8, s[34:35] offset:128
  global_load_ushort v12, v9, s[34:35] offset:256
L_e_noc:
  s_cmp_lt_u32 s2, 240
  s_cbranch_scc0 L_e_nomod
  s_add_u32 m0, s61, 0
  s_nop 0
  global_load_lds_dwordx4 v16, s[56:57] nt
  s_add_u32 m0, s61, 4096
  s_nop 0
  global_load_lds_dwordx4 v17, s[56:57] nt
  s_add_u32 m0, s61, 8192
  s_nop 0
  global_load_lds_dwordx4 v18, s[56:57] nt
  s_add_u32 m0, s61, 12288
  s_nop 0
  global_load_lds_dwordx4 v19, s[56:57] nt
  s_add_u32 m0, s61, 16384
  s_nop 0
  global_load_lds_dwordx4 v20, s[56:57] nt
L_e_nomod:
  s_barrier
  s_setprio 1
  s_cmp_eq_u32 s9, 1
  s_cbranch_scc0 L_e_nox
  v_lshlrev_b32 v8, 2, v1
  global_load_dword v10, v8, s[16:17] offset:0
  global_load_dword v11, v8, s[16:17] offset:256
  global_load_dword v12, v8, s[16:17] offset:512
  global_load_dword v13, v8, s[16:17] offset:768
  global_load_dword v14, v8, s[16:17] offset:1024
  s_mul_i32 s10, s7, 160
  v_min_u32 v9, 39, v1
  v_lshl_add_u32 v8, v9, 2, s10
  global_load_dword v15, v8, s[16:17]
L_e_nox:
  s_waitcnt lgkmcnt(0)
  s_mul_i32 s44, s44, 0x19660d
  s_add_u32 s44, s44, 0x3c6ef35f
  s_mov_b32 s45, 0x7060500
  s_mov_b32 s46, 0x7060501
  s_mov_b32 s47, 0x7060502
  s_mov_b32 s48, 0x7060503
  s_bfe_u32 s49, s44, 0x80000
  s_bfe_u32 s50, s44, 0x80008
  s_bfe_u32 s51, s44, 0x80010
  s_bfe_u32 s60, s44, 0x80018
  s_mov_b32 s52, 0xffff0000
  s_mov_b32 s53, 0x3fb8aa3b
  s_mov_b32 s54, 0x3d93cd3a
  v_and_b32 v28, 1, v1
  v_lshlrev_b32 v28, 4, v28
  v_mov_b32 v29, 0xffff
  v_lshlrev_b32 v29, v28, v29
  v_lshrrev_b32 v28, 1, v3
  v_cmp_eq_u32 vcc, 0, v28
  s_nop 1
  v_cndmask_b32 v4, 0, v29, vcc
  v_cmp_eq_u32 vcc, 1, v28
  s_nop 1
  v_cndmask_b32 v5, 0, v29, vcc
  v_cmp_eq_u32 vcc, 2, v28
  s_nop 1
  v_cndmask_b32 v6, 0, v29, vcc
  v_cmp_eq_u32 vcc, 3, v28
  s_nop 1
  v_cndmask_b32 v7, 0, v29, vcc
  v_mov_b32 v30, 0
  v_mov_b32 v31, 1
  s_cmp_eq_u32 s9, 0
  s_cbranch_scc1 L_h0
  s_cmp_eq_u32 s9, 1
  s_cbranch_scc1 L_e_w1
  s_waitcnt vmcnt(0)
L_e_w1:
  s_waitcnt vmcnt(6)
  s_mov_b32 exec_lo, 0x1
  s_mov_b32 exec_hi, 0x0
  ds_add_u32 v30, v31 offset:31236
  s_mov_b64 exec, -1
  s_waitcnt vmcnt(0)
  s_cmp_eq_u32 s9, 1
  s_cbranch_scc1 L_h1
  s_cmp_eq_u32 s9, 2
  s_cbranch_scc1 L_qg
  s_getreg_b32 s10, hwreg(HW_REG_XCC_ID, 0, 4)
  v_mov_b32 v22, s10
  v_mov_b32 v23, s44
  s_lshl_b32 s10, s4, 11
  s_lshl_b32 s11, s5, 6
  s_add_u32 s10, s10, s11
  s_add_u32 s10, s10, 1523712
  v_mov_b32 v24, s10
  s_mov_b32 exec_lo, 0x1
  s_mov_b32 exec_hi, 0x0
  global_store_dwordx2 v24, v[22:23], s[42:43] sc1
  s_mov_b64 exec, -1
  s_branch L_qg
L_e_q:
  s_sub_u32 s12, s9, 4
  s_mul_i32 s10, s7, 983040
  s_mul_i32 s11, s6, 384
  s_add_u32 s15, s10, s11
  s_lshr_b32 s10, s12, 1
  s_lshl_b32 s10, s10, 4
  s_and_b32 s11, s12, 1
  s_add_u32 s10, s10, s11
  s_mul_i32 s10, s10, 12288
  s_add_u32 s15, s15, s10
  v_mul_u32_u24 v16, 24576, v2
  v_lshl_add_u32 v16, v3, 4, v16
  v_add_u32 v17, 393216, v16
  v_add_u32 v18, 786432, v16
  s_mul_i32 s62, s12, 3072
  s_waitcnt lgkmcnt(0)
  s_load_dword s44, s[42:43], 0
  s_add_u32 s58, s22, s15
  s_addc_u32 s59, s23, 0
  s_add_u32 m0, s62, 0
  s_nop 0
  global_load_lds_dwordx4 v16, s[58:59] offset:0 nt
  s_add_u32 m0, s62, 896
  s_nop 0
  global_load_lds_dwordx4 v16, s[58:59] offset:128 nt
  s_add_u32 m0, s62, 1792
  s_nop 0
  global_load_lds_dwordx4 v16, s[58:59] offset:256 nt
  s_add_u32 m0, s62, 12288
  s_nop 0
  global_load_lds_dwordx4 v17, s[58:59] offset:0 nt
  s_add_u32 m0, s62, 13184
  s_nop 0
  global_load_lds_dwordx4 v17, s[58:59] offset:128 nt
  s_add_u32 m0, s62, 14080
  s_nop 0
  global_load_lds_dwordx4 v17, s[58:59] offset:256 nt
  s_cmp_lt_u32 s12, 2
  s_cbranch_scc0 L_e_q2
  s_add_u32 m0, s62, 24576
  s_nop 0
  global_load_lds_dwordx4 v18, s[58:59] offset:0 nt
  s_add_u32 m0, s62, 25472
  s_nop 0
  global_load_lds_dwordx4 v18, s[58:59] offset:128 nt
  s_add_u32 m0, s62, 26368
  s_nop 0
  global_load_lds_dwordx4 v18, s[58:59] offset:256 nt
L_e_q2:
  s_barrier
  s_setprio 1
  s_waitcnt lgkmcnt(0)
  s_mul_i32 s44, s44, 0x19660d
  s_add_u32 s44, s44, 0x3c6ef35f
  s_mov_b32 s45, 0x7060500
  s_mov_b32 s46, 0x7060501
  s_mov_b32 s47, 0x7060502
  s_mov_b32 s48, 0x7060503
  s_bfe_u32 s49, s44, 0x80000
  s_bfe_u32 s50, s44, 0x80008
  s_bfe_u32 s51, s44, 0x80010
  s_bfe_u32 s60, s44, 0x80018
  s_mov_b32 s52, 0xffff0000
  s_mov_b32 s53, 0x3fb8aa3b
  s_mov_b32 s54, 0x3d93cd3a
  v_and_b32 v28, 1, v1
  v_lshlrev_b32 v28, 4, v28
  v_mov_b32 v29, 0xffff
  v_lshlrev_b32 v29, v28, v29
  v_lshrrev_b32 v28, 1, v3
  v_cmp_eq_u32 vcc, 0, v28
  s_nop 1
  v_cndmask_b32 v4, 0, v29, vcc
  v_cmp_eq_u32 vcc, 1, v28
  s_nop 1
  v_cndmask_b32 v5, 0, v29, vcc
  v_cmp_eq_u32 vcc, 2, v28
  s_nop 1
  v_cndmask_b32 v6, 0, v29, vcc
  v_cmp_eq_u32 vcc, 3, v28
  s_nop 1
  v_cndmask_b32 v7, 0, v29, vcc
  v_mov_b32 v30, 0
  v_mov_b32 v31, 1
  s_waitcnt vmcnt(0)
  s_mov_b32 exec_lo, 0x1
  s_mov_b32 exec_hi, 0x0
  ds_add_u32 v30, v31 offset:31240
  s_mov_b64 exec, -1
  s_branch L_qg
L_h0:
  s_cmp_lt_u32 s2, 240
  s_cbranch_scc0 L_hdone
  s_waitcnt vmcnt(5)
  s_mov_b32 s10, 0xbfb8aa3b
  s_mov_b32 s11, 0xb2a57060
  s_mov_b32 s14, 0x3f317218
  v_lshlrev_b32 v10, 16, v10
  v_lshlrev_b32 v11, 16, v11
  v_lshlrev_b32 v12, 16, v12
  v_max_f32 v10, 0xc2ae0000, v10
  v_max_f32 v11, 0xc2ae0000, v11
  v_max_f32 v12, 0xc2ae0000, v12
  v_min_f32 v24, 0x43000000, v10
  v_min_f32 v25, 0x43000000, v11
  v_min_f32 v26, 0x43000000, v12
  v_mul_f32 v16, s10, v24
  v_mul_f32 v17, s10, v25
  v_mul_f32 v18, s10, v26
  v_fma_f32 v20, v24, s10, -v16
  v_fma_f32 v21, v25, s10, -v17
  v_fma_f32 v22, v26, s10, -v18
  v_fma_f32 v20, v24, s11, v20
  v_fma_f32 v21, v25, s11, v21
  v_fma_f32 v22, v26, s11, v22
  v_exp_f32 v16, v16
  v_exp_f32 v17, v17
  v_exp_f32 v18, v18
  v_mul_f32 v20, s14, v20
  v_mul_f32 v21, s14, v21
  v_mul_f32 v22, s14, v22
  v_fma_f32 v16, v16, v20, v16
  v_fma_f32 v17, v17, v21, v17
  v_fma_f32 v18, v18, v22, v18
  v_add_f32 v16, 1.0, v16
  v_add_f32 v17, 1.0, v17
  v_add_f32 v18, 1.0, v18
  v_rcp_f32 v20, v16
  v_rcp_f32 v21, v17
  v_rcp_f32 v22, v18
  v_mul_f32 v24, v10, v20
  v_mul_f32 v25, v11, v21
  v_mul_f32 v26, v12, v22
  v_fma_f32 v16, -v24, v16, v10
  v_fma_f32 v17, -v25, v17, v11
  v_fma_f32 v18, -v26, v18, v12
  v_fma_f32 v24, v16, v20, v24
  v_fma_f32 v25, v17, v21, v25
  v_fma_f32 v26, v18, v22, v26
  v_cvt_pk_bf16_f32 v12, v24, v24
  v_cvt_pk_bf16_f32 v13, v25, v25
  v_cvt_pk_bf16_f32 v14, v26, v26
  v_lshlrev_b32 v8, 2, v2
  v_lshlrev_b32 v9, 4, v1
  ds_bpermute_b32 v112, v8, v12 offset:0
  ds_bpermute_b32 v113, v8, v12 offset:32
  ds_bpermute_b32 v114, v8, v12 offset:64
  ds_bpermute_b32 v115, v8, v12 offset:96
  ds_bpermute_b32 v116, v8, v12 offset:128
  ds_bpermute_b32 v117, v8, v12 offset:160
  ds_bpermute_b32 v118, v8, v12 offset:192
  ds_bpermute_b32 v119, v8, v12 offset:224
  ds_bpermute_b32 v120, v8, v13 offset:0
  ds_bpermute_b32 v121, v8, v13 offset:32
  ds_bpermute_b32 v122, v8, v13 offset:64
  ds_bpermute_b32 v123, v8, v13 offset:96
  ds_bpermute_b32 v124, v8, v13 offset:128
  ds_bpermute_b32 v125, v8, v13 offset:160
  ds_bpermute_b32 v126, v8, v13 offset:192
  ds_bpermute_b32 v127, v8, v13 offset:224
  ds_bpermute_b32 v16, v8, v14 offset:0
  ds_bpermute_b32 v17, v8, v14 offset:32
  ds_bpermute_b32 v18, v8, v14 offset:64
  ds_bpermute_b32 v19, v8, v14 offset:96
  s_waitcnt vmcnt(0)
  s_mov_b32 s55, 0
L_lp_37:
  ds_read_b32 v29, v30 offset:31236
  s_waitcnt lgkmcnt(0)
  v_cmp_ne_u32 vcc, 3, v29
  s_cbranch_vccz L_lpd_38
  s_sleep 1
  s_add_u32 s55, s55, 1
  s_cmp_lt_u32 s55, 16777216
  s_cbranch_scc1 L_lp_37
L_lpd_38:
  ds_read_b128 v[32:35], v9 offset:33792
  ds_read_b128 v[36:39], v9 offset:34816
  ds_read_b128 v[40:43], v9 offset:35840
  ds_read_b128 v[44:47], v9 offset:36864
  ds_read_b128 v[48:51], v9 offset:37888
  ds_read_b128 v[52:55], v9 offset:38912
  ds_read_b128 v[56:59], v9 offset:39936
  ds_read_b128 v[60:63], v9 offset:40960
  ds_read_b128 v[64:67], v9 offset:41984
  ds_read_b128 v[68:71], v9 offset:43008
  ds_read_b128 v[72:75], v9 offset:44032
  ds_read_b128 v[76:79], v9 offset:45056
  ds_read_b128 v[80:83], v9 offset:46080
  ds_read_b128 v[84:87], v9 offset:47104
  ds_read_b128 v[88:91], v9 offset:48128
  ds_read_b128 v[92:95], v9 offset:49152
  ds_read_b128 v[96:99], v9 offset:50176
  ds_read_b128 v[100:103], v9 offset:51200
  ds_read_b128 v[104:107], v9 offset:52224
  ds_read_b128 v[108:111], v9 offset:53248
  v_lshlrev_b32 v8, 6, v3
  v_and_b32 v10, 16, v1
  v_lshl_add_u32 v8, v10, 1, v8
  v_lshrrev_b32 v10, 5, v1
  v_lshl_add_u32 v8, v10, 4, v8
  s_mul_i32 s10, s12, 30720
  s_lshl_b32 s11, s13, 9
  s_add_u32 s10, s10, s11
  s_add_u32 s10, s10, 4096
  v_add_u32 v8, s10, v8
  s_waitcnt lgkmcnt(0)
  v_and_b32 v24, v112, v4
  v_and_b32 v25, v112, v5
  v_and_b32 v26, v112, v6
  v_and_b32 v27, v112, v7
  v_and_b32 v28, v113, v4
  v_and_b32 v29, v113, v5
  v_and_b32 v30, v113, v6
  v_and_b32 v31, v113, v7
  v_mfma_f32_16x16x32_bf16 v[20:23], v[24:27], v[32:35], 0
  v_and_b32 v24, v114, v4
  v_and_b32 v25, v114, v5
  v_and_b32 v26, v114, v6
  v_and_b32 v27, v114, v7
  v_mfma_f32_16x16x32_bf16 v[20:23], v[28:31], v[36:39], v[20:23]
  v_and_b32 v28, v115, v4
  v_and_b32 v29, v115, v5
  v_and_b32 v30, v115, v6
  v_and_b32 v31, v115, v7
  v_mfma_f32_16x16x32_bf16 v[20:23], v[24:27], v[40:43], v[20:23]
  v_and_b32 v24, v116, v4
  v_and_b32 v25, v116, v5
  v_and_b32 v26, v116, v6
  v_and_b32 v27, v116, v7
  v_mfma_f32_16x16x32_bf16 v[20:23], v[28:31], v[44:47], v[20:23]
  v_and_b32 v28, v117, v4
  v_and_b32 v29, v117, v5
  v_and_b32 v30, v117, v6
  v_and_b32 v31, v117, v7
  v_mfma_f32_16x16x32_bf16 v[20:23], v[24:27], v[48:51], v[20:23]
  v_and_b32 v24, v118, v4
  v_and_b32 v25, v118, v5
  v_and_b32 v26, v118, v6
  v_and_b32 v27, v118, v7
  v_mfma_f32_16x16x32_bf16 v[20:23], v[28:31], v[52:55], v[20:23]
  v_and_b32 v28, v119, v4
  v_and_b32 v29, v119, v5
  v_and_b32 v30, v119, v6
  v_and_b32 v31, v119, v7
  v_mfma_f32_16x16x32_bf16 v[20:23], v[24:27], v[56:59], v[20:23]
  v_and_b32 v24, v120, v4
  v_and_b32 v25, v120, v5
  v_and_b32 v26, v120, v6
  v_and_b32 v27, v120, v7
  v_mfma_f32_16x16x32_bf16 v[20:23], v[28:31], v[60:63], v[20:23]
  v_and_b32 v28, v121, v4
  v_and_b32 v29, v121, v5
  v_and_b32 v30, v121, v6
  v_and_b32 v31, v121, v7
  v_mfma_f32_16x16x32_bf16 v[20:23], v[24:27], v[64:67], v[20:23]
  v_and_b32 v24, v122, v4
  v_and_b32 v25, v122, v5
  v_and_b32 v26, v122, v6
  v_and_b32 v27, v122, v7
  v_mfma_f32_16x16x32_bf16 v[20:23], v[28:31], v[68:71], v[20:23]
  v_and_b32 v28, v123, v4
  v_and_b32 v29, v123, v5
  v_and_b32 v30, v123, v6
  v_and_b32 v31, v123, v7
  v_mfma_f32_16x16x32_bf16 v[20:23], v[24:27], v[72:75], v[20:23]
  v_and_b32 v24, v124, v4
  v_and_b32 v25, v124, v5
  v_and_b32 v26, v124, v6
  v_and_b32 v27, v124, v7
  v_mfma_f32_16x16x32_bf16 v[20:23], v[28:31], v[76:79], v[20:23]
  v_and_b32 v28, v125, v4
  v_and_b32 v29, v125, v5
  v_and_b32 v30, v125, v6
  v_and_b32 v31, v125, v7
  v_mfma_f32_16x16x32_bf16 v[20:23], v[24:27], v[80:83], v[20:23]
  v_and_b32 v24, v126, v4
  v_and_b32 v25, v126, v5
  v_and_b32 v26, v126, v6
  v_and_b32 v27, v126, v7
  v_mfma_f32_16x16x32_bf16 v[20:23], v[28:31], v[84:87], v[20:23]
  v_and_b32 v28, v127, v4
  v_and_b32 v29, v127, v5
  v_and_b32 v30, v127, v6
  v_and_b32 v31, v127, v7
  v_mfma_f32_16x16x32_bf16 v[20:23], v[24:27], v[88:91], v[20:23]
  v_and_b32 v24, v16, v4
  v_and_b32 v25, v16, v5
  v_and_b32 v26, v16, v6
  v_and_b32 v27, v16, v7
  v_mfma_f32_16x16x32_bf16 v[20:23], v[28:31], v[92:95], v[20:23]
  v_and_b32 v28, v17, v4
  v_and_b32 v29, v17, v5
  v_and_b32 v30, v17, v6
  v_and_b32 v31, v17, v7
  v_mfma_f32_16x16x32_bf16 v[20:23], v[24:27], v[96:99], v[20:23]
  v_and_b32 v24, v18, v4
  v_and_b32 v25, v18, v5
  v_and_b32 v26, v18, v6
  v_and_b32 v27, v18, v7
  v_mfma_f32_16x16x32_bf16 v[20:23], v[28:31], v[100:103], v[20:23]
  v_and_b32 v28, v19, v4
  v_and_b32 v29, v19, v5
  v_and_b32 v30, v19, v6
  v_and_b32 v31, v19, v7
  v_mfma_f32_16x16x32_bf16 v[20:23], v[24:27], v[104:107], v[20:23]
  s_nop 0
  v_mfma_f32_16x16x32_bf16 v[20:23], v[28:31], v[108:111], v[20:23]
  s_nop 7
  v_permlane32_swap_b32 v20, v22
  v_permlane32_swap_b32 v21, v23
  s_nop 0
  v_add_f32_dpp v24, v22, v20 row_ror:8 row_mask:0xf bank_mask:0xf
  v_add_f32_dpp v26, v23, v21 row_ror:8 row_mask:0xf bank_mask:0xf
  v_mov_b32 v25, s44
  v_mov_b32 v27, s44
  s_mov_b32 exec_lo, 0xff00ff
  s_mov_b32 exec_hi, 0xff00ff
  global_store_dwordx4 v8, v[24:27], s[42:43] sc1
  s_mov_b64 exec, -1
  s_branch L_hdone
L_h1:
  v_lshlrev_b32 v16, 16, v10
  v_and_b32 v17, s52, v10
  v_lshlrev_b32 v18, 16, v11
  v_and_b32 v19, s52, v11
  v_lshlrev_b32 v20, 16, v12
  v_and_b32 v21, s52, v12
  v_lshlrev_b32 v22, 16, v13
  v_and_b32 v23, s52, v13
  v_lshlrev_b32 v24, 16, v14
  v_and_b32 v25, s52, v14
  v_add_f32 v10, v16, v17
  v_add_f32 v10, v10, v18
  v_add_f32 v10, v10, v19
  v_add_f32 v10, v10, v20
  v_add_f32 v10, v10, v21
  v_add_f32 v10, v10, v22
  v_add_f32 v10, v10, v23
  v_add_f32 v10, v10, v24
  v_add_f32 v10, v10, v25
  s_nop 1
  v_add_f32_dpp v10, v10, v10 quad_perm:[1,0,3,2] row_mask:0xf bank_mask:0xf
  s_nop 1
  v_add_f32_dpp v10, v10, v10 quad_perm:[2,3,0,1] row_mask:0xf bank_mask:0xf
  s_nop 1
  v_add_f32_dpp v10, v10, v10 row_half_mirror row_mask:0xf bank_mask:0xf
  s_nop 1
  v_add_f32_dpp v10, v10, v10 row_ror:8 row_mask:0xf bank_mask:0xf
  v_mov_b32 v11, v10
  s_nop 1
  v_permlane16_swap_b32 v10, v11
  v_add_f32 v10, v10, v11
  v_mov_b32 v11, v10
  s_nop 1
  v_permlane32_swap_b32 v10, v11
  v_add_f32 v10, v10, v11
  v_mul_f32 v10, 0x3acccccd, v10
  v_sub_f32 v16, v16, v10
  v_sub_f32 v17, v17, v10
  v_sub_f32 v18, v18, v10
  v_sub_f32 v19, v19, v10
  v_sub_f32 v20, v20, v10
  v_sub_f32 v21, v21, v10
  v_sub_f32 v22, v22, v10
  v_sub_f32 v23, v23, v10
  v_sub_f32 v24, v24, v10
  v_sub_f32 v25, v25, v10
  v_mul_f32 v11, v16, v16
  v_fmac_f32 v11, v17, v17
  v_fmac_f32 v11, v18, v18
  v_fmac_f32 v11, v19, v19
  v_fmac_f32 v11, v20, v20
  v_fmac_f32 v11, v21, v21
  v_fmac_f32 v11, v22, v22
  v_fmac_f32 v11, v23, v23
  v_fmac_f32 v11, v24, v24
  v_fmac_f32 v11, v25, v25
  s_nop 1
  v_add_f32_dpp v11, v11, v11 quad_perm:[1,0,3,2] row_mask:0xf bank_mask:0xf
  s_nop 1
  v_add_f32_dpp v11, v11, v11 quad_perm:[2,3,0,1] row_mask:0xf bank_mask:0xf
  s_nop 1
  v_add_f32_dpp v11, v11, v11 row_half_mirror row_mask:0xf bank_mask:0xf
  s_nop 1
  v_add_f32_dpp v11, v11, v11 row_ror:8 row_mask:0xf bank_mask:0xf
  v_mov_b32 v12, v11
  s_nop 1
  v_permlane16_swap_b32 v11, v12
  v_add_f32 v11, v11, v12
  v_mov_b32 v12, v11
  s_nop 1
  v_permlane32_swap_b32 v11, v12
  v_add_f32 v11, v11, v12
  v_mul_f32 v11, 0x3acccccd, v11
  v_cvt_pk_bf16_f32 v10, v10, v10
  v_cvt_pk_bf16_f32 v11, v11, v11
  v_and_b32 v10, s52, v10
  v_and_b32 v11, s52, v11
  v_add_f32 v11, 0x3727c5ac, v11
  v_cvt_pk_bf16_f32 v11, v11, v11
  v_and_b32 v11, s52, v11
  v_sqrt_f32 v11, v11
  s_nop 0
  v_cvt_pk_bf16_f32 v11, v11, v11
  v_and_b32 v11, s52, v11
  v_rcp_f32 v11, v11
  v_lshlrev_b32 v12, 16, v15
  v_and_b32 v13, s52, v15
  v_sub_f32 v12, v12, v10
  v_sub_f32 v13, v13, v10
  v_cvt_pk_bf16_f32 v12, v12, v12
  v_cvt_pk_bf16_f32 v13, v13, v13
  v_and_b32 v12, s52, v12
  v_and_b32 v13, s52, v13
  v_mul_f32 v12, v12, v11
  v_mul_f32 v13, v13, v11
  v_cvt_pk_bf16_f32 v12, v12, v12
  v_cvt_pk_bf16_f32 v13, v13, v13
  v_and_b32 v12, s52, v12
  v_and_b32 v13, s52, v13
  s_mul_i32 s10, s7, 640
  s_add_u32 s10, s10, 6656
  v_lshl_add_u32 v16, v9, 4, s10
  v_add_u32 v17, 30720, v16
  v_add_u32 v18, 61440, v16
  v_add_u32 v19, 92160, v16
  s_mov_b32 s55, 0
L_lp_39:
  ds_read_b32 v29, v30 offset:31240
  s_waitcnt lgkmcnt(0)
  v_cmp_ne_u32 vcc, 4, v29
  s_cbranch_vccz L_lpd_40
  s_sleep 1
  s_add_u32 s55, s55, 1
  s_cmp_lt_u32 s55, 16777216
  s_cbranch_scc1 L_lp_39
L_lpd_40:
  v_lshlrev_b32 v8, 2, v2
  v_lshlrev_b32 v9, 4, v1
  ds_read_b128 v[64:67], v9 offset:0
  ds_read_b128 v[68:71], v9 offset:1024
  ds_read_b128 v[72:75], v9 offset:2048
  ds_read_b128 v[76:79], v9 offset:3072
  ds_read_b128 v[80:83], v9 offset:4096
  ds_read_b128 v[84:87], v9 offset:5120
  ds_read_b128 v[88:91], v9 offset:6144
  ds_read_b128 v[92:95], v9 offset:7168
  ds_read_b128 v[96:99], v9 offset:8192
  ds_read_b128 v[100:103], v9 offset:9216
  ds_read_b128 v[104:107], v9 offset:10240
  ds_read_b128 v[108:111], v9 offset:11264
  ds_read_b128 v[112:115], v9 offset:12288
  ds_read_b128 v[116:119], v9 offset:13312
  ds_read_b128 v[120:123], v9 offset:14336
  s_lshl_b32 s10, s4, 11
  s_add_u32 s10, s10, 1523712
  v_and_b32 v26, 31, v1
  v_lshl_add_u32 v26, v26, 6, s10
  s_mul_i32 s10, s7, 640
  s_add_u32 s10, s10, 4096
  s_mov_b32 s55, 0
  s_add_u32 s64, s42, s10
  s_addc_u32 s65, s43, 0
L_sp_41:
  s_load_dword s80, s[64:65], 4 glc
  s_load_dword s81, s[64:65], 636 glc
  s_load_dword s82, s[64:65], 5124 glc
  s_load_dword s83, s[64:65], 5756 glc
  s_load_dword s84, s[64:65], 30724 glc
  s_load_dword s85, s[64:65], 31356 glc
  s_load_dword s86, s[64:65], 35844 glc
  s_load_dword s87, s[64:65], 36476 glc
  s_load_dword s88, s[64:65], 61444 glc
  s_load_dword s89, s[64:65], 62076 glc
  s_load_dword s90, s[64:65], 66564 glc
  s_load_dword s91, s[64:65], 67196 glc
  s_load_dword s92, s[64:65], 92164 glc
  s_load_dword s93, s[64:65], 92796 glc
  s_load_dword s94, s[64:65], 97284 glc
  s_load_dword s95, s[64:65], 97916 glc
  s_waitcnt lgkmcnt(0)
  s_xor_b32 s80, s80, s44
  s_xor_b32 s81, s81, s44
  s_xor_b32 s82, s82, s44
  s_xor_b32 s83, s83, s44
  s_xor_b32 s84, s84, s44
  s_xor_b32 s85, s85, s44
  s_xor_b32 s86, s86, s44
  s_xor_b32 s87, s87, s44
  s_xor_b32 s88, s88, s44
  s_xor_b32 s89, s89, s44
  s_xor_b32 s90, s90, s44
  s_xor_b32 s91, s91, s44
  s_xor_b32 s92, s92, s44
  s_xor_b32 s93, s93, s44
  s_xor_b32 s94, s94, s44
  s_xor_b32 s95, s95, s44
  s_or_b64 s[80:81], s[80:81], s[82:83]
  s_or_b64 s[80:81], s[80:81], s[84:85]
  s_or_b64 s[80:81], s[80:81], s[86:87]
  s_or_b64 s[80:81], s[80:81], s[88:89]
  s_or_b64 s[80:81], s[80:81], s[90:91]
  s_or_b64 s[80:81], s[80:81], s[92:93]
  s_or_b64 s[80:81], s[80:81], s[94:95]
  s_cbranch_scc0 L_spd_42
  s_sleep 2
  s_add_u32 s55, s55, 1
  s_cmp_lt_u32 s55, 1500000
  s_cbranch_scc1 L_sp_41
L_spd_42:
  s_mov_b32 s55, 0
L_gp_43:
  global_load_dwordx4 v[32:35], v16, s[42:43] offset:-2560 sc1
  global_load_dwordx4 v[36:39], v16, s[42:43] offset:2560 sc1
  global_load_dwordx4 v[40:43], v17, s[42:43] offset:-2560 sc1
  global_load_dwordx4 v[44:47], v17, s[42:43] offset:2560 sc1
  global_load_dwordx4 v[48:51], v18, s[42:43] offset:-2560 sc1
  global_load_dwordx4 v[52:55], v18, s[42:43] offset:2560 sc1
  global_load_dwordx4 v[56:59], v19, s[42:43] offset:-2560 sc1
  global_load_dwordx4 v[60:63], v19, s[42:43] offset:2560 sc1
  global_load_dwordx2 v[14:15], v26, s[42:43] sc1
  s_waitcnt vmcnt(0)
  v_xor_b32 v33, s44, v33
  v_xor_b32 v35, s44, v35
  v_xor_b32 v37, s44, v37
  v_xor_b32 v39, s44, v39
  v_xor_b32 v41, s44, v41
  v_xor_b32 v43, s44, v43
  v_xor_b32 v45, s44, v45
  v_xor_b32 v47, s44, v47
  v_xor_b32 v49, s44, v49
  v_xor_b32 v51, s44, v51
  v_xor_b32 v53, s44, v53
  v_xor_b32 v55, s44, v55
  v_xor_b32 v57, s44, v57
  v_xor_b32 v59, s44, v59
  v_xor_b32 v61, s44, v61
  v_xor_b32 v63, s44, v63
  v_xor_b32 v15, s44, v15
  v_or3_b32 v20, v33, v35, v37
  v_or3_b32 v20, v20, v39, v41
  v_or3_b32 v20, v20, v43, v45
  v_or3_b32 v20, v20, v47, v49
  v_or3_b32 v20, v20, v51, v53
  v_or3_b32 v20, v20, v55, v57
  v_or3_b32 v20, v20, v59, v61
  v_or3_b32 v20, v20, v63, v15
  v_cmp_ne_u32 vcc, 0, v20
  s_cbranch_vccz L_gpd_44
  s_mov_b64 exec, vcc
  s_sleep 4
  s_add_u32 s55, s55, 1
  s_cmp_lt_u32 s55, 1500000
  s_cbranch_scc1 L_gp_43
L_gpd_44:
  s_mov_b64 exec, -1
  s_getreg_b32 s10, hwreg(HW_REG_XCC_ID, 0, 4)
  v_cmp_ne_u32 vcc, s10, v14
  s_cmp_eq_u64 vcc, 0
  s_cselect_b32 s66, 1, 0
  v_mov_b32 v14, s66
  ds_write_b32 v30, v14 offset:31244
  v_add_f32 v20, v32, v40
  v_add_f32 v24, v48, v56
  v_add_f32 v20, v20, v24
  v_add_f32 v21, v34, v42
  v_add_f32 v24, v50, v58
  v_add_f32 v21, v21, v24
  v_add_f32 v22, v36, v44
  v_add_f32 v24, v52, v60
  v_add_f32 v22, v22, v24
  v_add_f32 v23, v38, v46
  v_add_f32 v24, v54, v62
  v_add_f32 v23, v23, v24
  v_cvt_pk_bf16_f32 v20, v20, v20
  v_cvt_pk_bf16_f32 v21, v21, v21
  v_cvt_pk_bf16_f32 v22, v22, v22
  v_cvt_pk_bf16_f32 v23, v23, v23
  v_and_b32 v20, s52, v20
  v_and_b32 v21, s52, v21
  v_and_b32 v22, s52, v22
  v_and_b32 v23, s52, v23
  v_add_f32 v22, 1.0, v22
  v_add_f32 v23, 1.0, v23
  v_cvt_pk_bf16_f32 v22, v22, v22
  v_cvt_pk_bf16_f32 v23, v23, v23
  v_and_b32 v22, s52, v22
  v_and_b32 v23, s52, v23
  v_mul_f32 v12, v12, v22
  v_mul_f32 v13, v13, v23
  v_cvt_pk_bf16_f32 v12, v12, v12
  v_cvt_pk_bf16_f32 v13, v13, v13
  v_and_b32 v12, s52, v12
  v_and_b32 v13, s52, v13
  v_add_f32 v12, v12, v20
  v_add_f32 v13, v13, v21
  v_cvt_pk_bf16_f32 v12, v12, v12
  v_cvt_pk_bf16_f32 v13, v13, v13
  ds_bpermute_b32 v32, v8, v12 offset:0
  ds_bpermute_b32 v33, v8, v13 offset:0
  ds_bpermute_b32 v34, v8, v12 offset:32
  ds_bpermute_b32 v35, v8, v13 offset:32
  ds_bpermute_b32 v36, v8, v12 offset:64
  ds_bpermute_b32 v37, v8, v13 offset:64
  ds_bpermute_b32 v38, v8, v12 offset:96
  ds_bpermute_b32 v39, v8, v13 offset:96
  ds_bpermute_b32 v40, v8, v12 offset:128
  ds_bpermute_b32 v41, v8, v13 offset:128
  s_waitcnt lgkmcnt(0)
  v_and_b32 v44, v32, v4
  v_and_b32 v45, v32, v5
  v_and_b32 v46, v32, v6
  v_and_b32 v47, v32, v7
  v_and_b32 v48, v33, v4
  v_and_b32 v49, v33, v5
  v_and_b32 v50, v33, v6
  v_and_b32 v51, v33, v7
  v_mfma_f32_16x16x32_bf16 v[16:19], v[44:47], v[64:67], 0
  v_mfma_f32_16x16x32_bf16 v[20:23], v[44:47], v[68:71], 0
  v_mfma_f32_16x16x32_bf16 v[24:27], v[44:47], v[72:75], 0
  v_and_b32 v44, v34, v4
  v_and_b32 v45, v34, v5
  v_and_b32 v46, v34, v6
  v_and_b32 v47, v34, v7
  v_mfma_f32_16x16x32_bf16 v[16:19], v[48:51], v[76:79], v[16:19]
  v_mfma_f32_16x16x32_bf16 v[20:23], v[48:51], v[80:83], v[20:23]
  v_mfma_f32_16x16x32_bf16 v[24:27], v[48:51], v[84:87], v[24:27]
  v_and_b32 v48, v35, v4
  v_and_b32 v49, v35, v5
  v_and_b32 v50, v35, v6
  v_and_b32 v51, v35, v7
  v_mfma_f32_16x16x32_bf16 v[16:19], v[44:47], v[88:91], v[16:19]
  v_mfma_f32_16x16x32_bf16 v[20:23], v[44:47], v[92:95], v[20:23]
  v_mfma_f32_16x16x32_bf16 v[24:27], v[44:47], v[96:99], v[24:27]
  v_and_b32 v44, v36, v4
  v_and_b32 v45, v36, v5
  v_and_b32 v46, v36, v6
  v_and_b32 v47, v36, v7
  v_mfma_f32_16x16x32_bf16 v[16:19], v[48:51], v[100:103], v[16:19]
  v_mfma_f32_16x16x32_bf16 v[20:23], v[48:51], v[104:107], v[20:23]
  v_mfma_f32_16x16x32_bf16 v[24:27], v[48:51], v[108:111], v[24:27]
  v_mfma_f32_16x16x32_bf16 v[16:19], v[44:47], v[112:115], v[16:19]
  v_mfma_f32_16x16x32_bf16 v[20:23], v[44:47], v[116:119], v[20:23]
  v_mfma_f32_16x16x32_bf16 v[24:27], v[44:47], v[120:123], v[24:27]
  s_nop 7
  ds_read_b128 v[64:67], v9 offset:15360
  ds_read_b128 v[68:71], v9 offset:16384
  ds_read_b128 v[72:75], v9 offset:17408
  ds_read_b128 v[76:79], v9 offset:18432
  ds_read_b128 v[80:83], v9 offset:19456
  ds_read_b128 v[84:87], v9 offset:20480
  ds_read_b128 v[88:91], v9 offset:21504
  ds_read_b128 v[92:95], v9 offset:22528
  ds_read_b128 v[96:99], v9 offset:23552
  ds_read_b128 v[100:103], v9 offset:24576
  ds_read_b128 v[104:107], v9 offset:25600
  ds_read_b128 v[108:111], v9 offset:26624
  ds_read_b128 v[112:115], v9 offset:27648
  ds_read_b128 v[116:119], v9 offset:28672
  ds_read_b128 v[120:123], v9 offset:29696
  s_mul_i32 s10, s6, 6144
  s_lshl_b32 s11, s7, 4
  s_add_u32 s11, s10, s11
  s_add_u32 s11, s11, 131072
  v_lshl_add_u32 v8, v3, 8, s11
  v_and_b32 v10, 16, v1
  v_lshl_add_u32 v8, v10, 3, v8
  v_add_u32 v11, 4096, v8
  v_lshrrev_b32 v10, 5, v1
  v_lshl_add_u32 v8, v10, 11, v8
  v_mov_b32 v10, s44
  s_waitcnt lgkmcnt(0)
  v_and_b32 v44, v37, v4
  v_and_b32 v45, v37, v5
  v_and_b32 v46, v37, v6
  v_and_b32 v47, v37, v7
  v_and_b32 v48, v38, v4
  v_and_b32 v49, v38, v5
  v_and_b32 v50, v38, v6
  v_and_b32 v51, v38, v7
  v_mfma_f32_16x16x32_bf16 v[16:19], v[44:47], v[64:67], v[16:19]
  v_mfma_f32_16x16x32_bf16 v[20:23], v[44:47], v[68:71], v[20:23]
  v_mfma_f32_16x16x32_bf16 v[24:27], v[44:47], v[72:75], v[24:27]
  v_and_b32 v44, v39, v4
  v_and_b32 v45, v39, v5
  v_and_b32 v46, v39, v6
  v_and_b32 v47, v39, v7
  v_mfma_f32_16x16x32_bf16 v[16:19], v[48:51], v[76:79], v[16:19]
  v_mfma_f32_16x16x32_bf16 v[20:23], v[48:51], v[80:83], v[20:23]
  v_mfma_f32_16x16x32_bf16 v[24:27], v[48:51], v[84:87], v[24:27]
  v_and_b32 v48, v40, v4
  v_and_b32 v49, v40, v5
  v_and_b32 v50, v40, v6
  v_and_b32 v51, v40, v7
  v_mfma_f32_16x16x32_bf16 v[16:19], v[44:47], v[88:91], v[16:19]
  v_mfma_f32_16x16x32_bf16 v[20:23], v[44:47], v[92:95], v[20:23]
  v_mfma_f32_16x16x32_bf16 v[24:27], v[44:47], v[96:99], v[24:27]
  v_and_b32 v44, v41, v4
  v_and_b32 v45, v41, v5
  v_and_b32 v46, v41, v6
  v_and_b32 v47, v41, v7
  v_mfma_f32_16x16x32_bf16 v[16:19], v[48:51], v[100:103], v[16:19]
  v_mfma_f32_16x16x32_bf16 v[20:23], v[48:51], v[104:107], v[20:23]
  v_mfma_f32_16x16x32_bf16 v[24:27], v[48:51], v[108:111], v[24:27]
  v_mfma_f32_16x16x32_bf16 v[16:19], v[44:47], v[112:115], v[16:19]
  v_mfma_f32_16x16x32_bf16 v[20:23], v[44:47], v[116:119], v[20:23]
  v_mfma_f32_16x16x32_bf16 v[24:27], v[44:47], v[120:123], v[24:27]
  s_nop 6
  v_permlane32_swap_b32 v16, v20
  v_permlane32_swap_b32 v17, v21
  v_permlane32_swap_b32 v18, v22
  v_permlane32_swap_b32 v19, v23
  v_add_f32_dpp v16, v20, v16 row_ror:8 row_mask:0xf bank_mask:0xf
  v_add_f32_dpp v17, v21, v17 row_ror:8 row_mask:0xf bank_mask:0xf
  v_add_f32_dpp v18, v22, v18 row_ror:8 row_mask:0xf bank_mask:0xf
  v_add_f32_dpp v19, v23, v19 row_ror:8 row_mask:0xf bank_mask:0xf
  v_permlane32_swap_b32 v24, v52
  v_permlane32_swap_b32 v25, v53
  v_permlane32_swap_b32 v26, v54
  v_permlane32_swap_b32 v27, v55
  v_add_f32_dpp v24, v52, v24 row_ror:8 row_mask:0xf bank_mask:0xf
  v_add_f32_dpp v25, v53, v25 row_ror:8 row_mask:0xf bank_mask:0xf
  v_add_f32_dpp v26, v54, v26 row_ror:8 row_mask:0xf bank_mask:0xf
  v_add_f32_dpp v27, v55, v27 row_ror:8 row_mask:0xf bank_mask:0xf
  v_add_u32 v16, 0x80, v16
  v_add_u32 v17, 0x80, v17
  v_add_u32 v18, 0x80, v18
  v_add_u32 v19, 0x80, v19
  v_add_u32 v24, 0x80, v24
  v_add_u32 v25, 0x80, v25
  v_add_u32 v26, 0x80, v26
  v_add_u32 v27, 0x80, v27
  v_perm_b32 v16, v16, v10, s45
  v_perm_b32 v17, v17, v10, s46
  v_perm_b32 v18, v18, v10, s47
  v_perm_b32 v19, v19, v10, s48
  v_perm_b32 v24, v24, v10, s45
  v_perm_b32 v25, v25, v10, s46
  v_perm_b32 v26, v26, v10, s47
  v_perm_b32 v27, v27, v10, s48
  s_mov_b32 exec_lo, 0xff00ff
  s_mov_b32 exec_hi, 0xff00ff
  s_cmp_eq_u32 s66, 1
  s_cbranch_scc0 L_ls_45
  global_store_dwordx4 v8, v[16:19], s[42:43]
  s_mov_b32 exec_hi, 0
  global_store_dwordx4 v11, v[24:27], s[42:43]
  s_branch L_lsd_46
L_ls_45:
  global_store_dwordx4 v8, v[16:19], s[42:43] sc1
  s_mov_b32 exec_hi, 0
  global_store_dwordx4 v11, v[24:27], s[42:43] sc1
L_lsd_46:
  s_mov_b64 exec, -1
  ds_write_b32 v30, v31 offset:31344
  s_branch L_hdone
L_qg:
  s_mov_b32 s55, 0
L_lp_47:
  ds_read_b32 v29, v30 offset:31344
  s_waitcnt lgkmcnt(0)
  v_cmp_ne_u32 vcc, 1, v29
  s_cbranch_vccz L_lpd_48
  s_sleep 1
  s_add_u32 s55, s55, 1
  s_cmp_lt_u32 s55, 16777216
  s_cbranch_scc1 L_lp_47
L_lpd_48:
  s_sub_u32 s12, s9, 2
  v_mov_b32 v28, 0
  s_mul_i32 s10, s6, 6144
  s_lshl_b32 s11, s12, 10
  s_add_u32 s10, s10, s11
  s_add_u32 s10, s10, 131072
  v_lshl_add_u32 v12, v1, 4, s10
  s_mov_b32 s55, 0
L_gp_49:
  global_load_dwordx4 v[8:11], v12, s[42:43] sc1
  s_waitcnt vmcnt(0)
  v_xor_b32 v8, s49, v8
  v_xor_b32 v9, s50, v9
  v_xor_b32 v10, s51, v10
  v_xor_b32 v11, s60, v11
  v_or3_b32 v13, v8, v9, v10
  v_or_b32 v13, v13, v11
  v_and_b32 v13, 0xff, v13
  v_cmp_ne_u32 vcc, 0, v13
  s_cbranch_vccz L_gpd_50
  s_mov_b64 exec, vcc
  s_sleep 2
  s_add_u32 s55, s55, 1
  s_cmp_lt_u32 s55, 1500000
  s_cbranch_scc1 L_gp_49
L_gpd_50:
  s_mov_b64 exec, -1
  v_add_f32_dpp v8, v8, v8 row_half_mirror row_mask:0xf bank_mask:0x5
  v_add_f32_dpp v9, v9, v9 row_half_mirror row_mask:0xf bank_mask:0x5
  s_nop 0
  v_add_f32_dpp v8, v10, v10 row_half_mirror row_mask:0xf bank_mask:0xa
  v_add_f32_dpp v9, v11, v11 row_half_mirror row_mask:0xf bank_mask:0xa
  s_nop 0
  v_add_f32_dpp v8, v8, v8 quad_perm:[1,0,3,2] row_mask:0xf bank_mask:0xf
  v_add_f32_dpp v9, v9, v9 quad_perm:[1,0,3,2] row_mask:0xf bank_mask:0xf
  s_nop 0
  v_add_f32_dpp v8, v8, v8 quad_perm:[2,3,0,1] row_mask:0xf bank_mask:0xf
  v_add_f32_dpp v9, v9, v9 quad_perm:[2,3,0,1] row_mask:0xf bank_mask:0xf
  v_cvt_pk_bf16_f32 v8, v8, v9
  s_lshl_b32 s10, s12, 6
  v_and_b32 v9, 60, v1
  v_add_u32 v9, s10, v9
  v_mov_b32 v10, 1
  ds_write_b32 v9, v8 offset:30720
  s_waitcnt lgkmcnt(0)
  s_mov_b32 exec_lo, 0x1
  s_mov_b32 exec_hi, 0x0
  ds_add_u32 v28, v10 offset:31232
  s_mov_b64 exec, -1
L_hdone:
  s_setprio 0
  s_waitcnt vmcnt(0)
  s_branch L_kvload
L_end:
L_exit:
  s_endpgm
.section .rodata,"a"
.p2align 6
.amdhsa_kernel adaLN_cond__sliding_block_cached__geglu_ffn__decode_kernel
.amdhsa_next_free_vgpr 128
.amdhsa_next_free_sgpr 102
.amdhsa_accum_offset 128
.amdhsa_group_segment_fixed_size 0
.amdhsa_kernarg_size 112
.amdhsa_user_sgpr_count 2
.amdhsa_user_sgpr_kernarg_segment_ptr 1
.amdhsa_system_sgpr_workgroup_id_x 1
.amdhsa_float_denorm_mode_32 3
.end_amdhsa_kernel
```
